```python
import torch

def _softmax(x, axis=-1):
    return torch.softmax(x, dim=axis)
def _gelu(x):
    return torch.nn.functional.gelu(x, approximate="tanh")
def _silu(x):
    return torch.nn.functional.silu(x)
def _sigmoid(x):
    return torch.sigmoid(x)
def _layernorm(x, axis=-1, eps=1e-5):
    m = x.mean(dim=axis, keepdim=True)
    v = x.var(dim=axis, keepdim=True, unbiased=False)
    return (x - m) / torch.sqrt(v + eps)
def _scatter_add(tgt, idx, src, axis=0):
    return tgt.clone().index_add_(axis, idx, src)
def _segment_sum(src, seg, n):
    out = torch.zeros((n,) + src.shape[1:], dtype=src.dtype)
    return out.index_add_(0, seg, src)
def _pad(x, pw):
    flat = tuple(v for pair in reversed(pw) for v in pair)
    return torch.nn.functional.pad(x, flat)

kernel_name = 'recurrent_scan__sliding_block_cached__glu_gated_reglu__decode'

def setup_inputs():

    _w = (lambda a: (lambda t: t.to(torch.bfloat16) if t.is_floating_point() else t)(torch.as_tensor(a)))
    def _A_setup():
        B, Sq, D = 4, 1, 448
        Hq, Hkv, Sk, Dh = 16, 8, 4096, 256
        assert Hq % Hkv == 0, (Hq, Hkv)
        return {
            "x": _w((lambda *s: torch.randn(*s, dtype=torch.bfloat16) * 0.05)(B, Sq, D)),
            "k_cache": _w((lambda *s: torch.randn(*s, dtype=torch.bfloat16) * 1.6)(B, Hkv, Sk, Dh)),
            "v_cache": _w((lambda *s: torch.randn(*s, dtype=torch.bfloat16) * 1.6)(B, Hkv, Sk, Dh)),
            "wq": _w((lambda *s: torch.randn(*s, dtype=torch.bfloat16) * 1.6)(D, Hq * Dh) * (D ** -0.5)),
            "wo": _w((lambda *s: torch.randn(*s, dtype=torch.bfloat16) * 1.6)(Hq * Dh, D) * ((Hq * Dh) ** -0.5)),
        }
    _A_in = _A_setup()

    def _B_setup():
        B, S, D, F = 4, 1, 448, 1792
        return {
            "x": _w((lambda *s: torch.randn(*s, dtype=torch.bfloat16) * 0.05)(B, S, D)),
            "W_gate": _w((lambda *s: torch.randn(*s, dtype=torch.bfloat16) * 0.2)(D, F) * (2.0 / D) ** 0.5),
            "W_up": _w((lambda *s: torch.randn(*s, dtype=torch.bfloat16) * 0.2)(D, F) * (2.0 / D) ** 0.5),
            "W_down": _w((lambda *s: torch.randn(*s, dtype=torch.bfloat16) * 0.2)(F, D) * (1.0 / F) ** 0.5),
        }
    _B_in = _B_setup()

    return {
        "A_x": _A_in["x"],
        "A_k_cache": _A_in["k_cache"],
        "A_v_cache": _A_in["v_cache"],
        "A_wq": _A_in["wq"],
        "A_wo": _A_in["wo"],
        "B_x": _B_in["x"],
        "B_W_gate": _B_in["W_gate"],
        "B_W_up": _B_in["W_up"],
        "B_W_down": _B_in["W_down"],
    }

def reference(A_x, A_k_cache, A_v_cache, A_wq, A_wo, B_x, B_W_gate, B_W_up, B_W_down):
    def _A_ref(x, k_cache, v_cache, wq, wo):
        B, Sq, D = x.shape
        Hq, Dh = 16, 256
        Hkv, Sk = k_cache.shape[1], k_cache.shape[2]
        W = min(4096, max(256, Sk // 4))
        rep = Hq // Hkv
        q = (lambda x, *d: x.permute(*d))((x @ wq).reshape(B, Sq, Hq, Dh), 0, 2, 1, 3)
        k = (lambda x, n, axis: torch.repeat_interleave(x, n, dim=axis))(k_cache[:, :, Sk - W:, :], rep, axis=1)
        v = (lambda x, n, axis: torch.repeat_interleave(x, n, dim=axis))(v_cache[:, :, Sk - W:, :], rep, axis=1)
        scores = torch.einsum("bhqd,bhkd->bhqk", q, k) * (Dh ** -0.5)
        p = _softmax(scores, axis=-1)
        o = torch.einsum("bhqk,bhkd->bhqd", p, v)
        return (lambda x, *d: x.permute(*d))(o, 0, 2, 1, 3).reshape(B, Sq, Hq * Dh) @ wo

    def _B_ref(x, W_gate, W_up, W_down):
        gate = torch.einsum("bsd,df->bsf", x, W_gate)
        up = torch.einsum("bsd,df->bsf", x, W_up)
        gate = gate * (lambda x, dt: x.to(dt))(gate > 0, gate.dtype)
        h = gate * up
        return torch.einsum("bsf,fd->bsd", h, W_down)

    x = A_x
    xn = _layernorm(x, axis=-1)
    s = _A_ref(xn, A_k_cache, A_v_cache, A_wq, A_wo)
    g = _silu(_B_ref(xn, B_W_gate, B_W_up, B_W_down))
    return x + s * g
```

```asm
; @launch grid=(256,1,1) block=(384,1,1) lds=163840
.amdgcn_target "amdgcn-amd-amdhsa--gfx950"
.text
.globl recurrent_scan__sliding_block_cached__glu_gated_reglu__decode_kernel
.p2align 8
.type recurrent_scan__sliding_block_cached__glu_gated_reglu__decode_kernel,@function
recurrent_scan__sliding_block_cached__glu_gated_reglu__decode_kernel:
    s_cmpk_ge_u32 s2, 256
    s_cbranch_scc1 L_end
    s_load_dwordx16 s[4:19], s[0:1], 0
    s_load_dwordx8 s[20:27], s[0:1], 64
    v_lshrrev_b32 v1, 6, v0
    v_and_b32 v0, 63, v0
    v_readfirstlane_b32 s3, v1
    s_and_b32 s28, s2, 7
    s_lshr_b32 s29, s2, 3
    s_and_b32 s30, s29, 3
    s_lshr_b32 s31, s29, 2
    s_cmp_eq_u32 s3, 4
    s_cbranch_scc1 L_lstart
    s_cmp_lt_u32 s3, 4
    s_cbranch_scc1 L_cstart
L_hstart:
    s_getpc_b64 s[56:57]
L_pc:
    v_lshlrev_b32 v1, 7, v0
    global_load_dword v40, v1, s[56:57] offset:640
    v_add_u32 v1, 8192, v1
    global_load_dword v40, v1, s[56:57] offset:640
    s_mul_i32 s56, s29, 14
    v_and_b32 v7, 15, v0
    v_add_u32 v7, s56, v7
    v_lshrrev_b32 v6, 4, v0
    s_lshl_b32 s57, s28, 1
    v_add_u32 v6, s57, v6
    v_lshlrev_b32 v6, 9, v6
    v_lshl_add_u32 v6, v7, 13, v6
    s_lshl_b32 s59, s28, 2
    s_and_b32 s57, s28, 4
    s_sub_u32 s59, s59, s57
    s_add_u32 s59, s59, 3
    s_lshl_b32 s57, s57, 2
    s_max_u32 s59, s59, s57
    s_lshl_b32 s59, s59, 7
    s_movk_i32 s58, 3584
    v_mul_u32_u24 v7, s58, v7
    v_add_u32 v7, s59, v7
    s_mov_b64 exec, 0x3fff3fff
    s_waitcnt lgkmcnt(0)
    global_load_dword v40, v6, s[10:11] offset:384
    s_bfm_b64 exec, 14, 0
    global_load_dword v40, v7, s[16:17]
    global_load_dword v40, v7, s[18:19]
    s_cmp_eq_u32 s2, 0
    s_cbranch_scc1 L_probe
    s_branch L_helper
L_lstart:
    v_lshrrev_b32 v1, 5, v0
    v_and_b32 v2, 31, v0
    v_xor_b32 v6, v2, v1
    v_lshlrev_b32 v6, 4, v6
    v_lshl_add_u32 v8, v1, 9, v6
    v_xor_b32 v9, 32, v8
    v_xor_b32 v10, 64, v8
    v_xor_b32 v11, 96, v8
    s_lshl_b32 s57, s30, 8
    s_lshl_b32 s58, s28, 5
    s_add_u32 s57, s57, s58
    s_add_u32 s57, s57, s31
    s_add_u32 s57, s57, 24
    s_lshl_b32 s61, s57, 16
    s_mul_i32 s64, s2, 5120
    s_movk_i32 s63, 1024
    s_mov_b32 s66, 0xffff
    s_and_b32 s64, s64, s66
    s_mov_b32 s42, 65536
    s_mov_b32 s43, 0x20000
    s_waitcnt lgkmcnt(0)
    s_add_u32 s40, s6, s61
    s_addc_u32 s41, s7, 0
    s_mov_b32 m0, 65536
    s_nop 0
    buffer_load_dwordx4 v8, s[40:43], s64 offen nt lds
    s_add_u32 m0, m0, s63
    s_add_u32 s64, s64, s63
    s_and_b32 s64, s64, s66
    buffer_load_dwordx4 v9, s[40:43], s64 offen nt lds
    s_add_u32 m0, m0, s63
    s_add_u32 s64, s64, s63
    s_and_b32 s64, s64, s66
    buffer_load_dwordx4 v10, s[40:43], s64 offen nt lds
    s_add_u32 m0, m0, s63
    s_add_u32 s64, s64, s63
    s_and_b32 s64, s64, s66
    buffer_load_dwordx4 v11, s[40:43], s64 offen nt lds
    s_branch L_loader
L_cstart:
    v_lshrrev_b32 v5, 4, v0
    v_lshrrev_b32 v1, 5, v0
    v_bfe_u32 v12, v0, 3, 2
    v_lshl_add_u32 v122, v1, 3, v12
    v_and_b32 v1, 7, v0
    v_lshlrev_b32 v12, 1, v5
    v_xor_b32 v1, v1, v12
    v_lshlrev_b32 v123, 4, v1
    v_lshlrev_b32 v121, 4, v0
    s_lshl_b32 s56, s28, 2
    s_sub_i32 s56, s56, 4
    s_mul_i32 s59, s28, 3
    s_min_i32 s56, s56, s59
    s_add_u32 s56, s56, s31
    s_lshl_b32 s59, s28, 3
    s_lshr_b32 s60, s29, 1
    s_add_u32 s59, s59, s60
    s_movk_i32 s58, 3584
    s_cmp_lt_u32 s29, 16
    s_cselect_b32 s33, s59, s56
    s_cselect_b32 s58, 8192, s58
    s_lshl_b32 s56, s33, 7
    s_and_b32 s57, s29, 1
    s_mul_i32 s59, s57, 56
    s_and_b32 s60, s3, 1
    s_lshl2_add_u32 s59, s60, s59
    s_lshr_b32 s60, s3, 1
    s_add_u32 s59, s59, s60
    s_mul_i32 s61, s59, s58
    s_lshl2_add_u32 s61, s61, s56
    v_mad_u32_u24 v122, v122, s58, v123
    s_movk_i32 s42, 896
    s_mul_i32 s46, s58, s42
    s_lshr_b32 s46, s46, 1
    s_and_b32 s34, s28, 4
    s_add_u32 s34, s34, s29
    s_cmp_lt_u32 s34, 32
    s_cselect_b32 s46, s46, 0
    s_mov_b32 s47, 0x20000
    s_lshl_b32 s62, s3, 10
    s_add_u32 m0, s62, 131072
    s_lshl_b32 s59, s58, 5
    s_mov_b32 s43, s47
    s_movk_i32 s60, 4096
    s_mul_i32 s62, s3, s42
    s_add_u32 s42, s42, s62
    s_waitcnt lgkmcnt(0)
    s_bitcmp0_b32 s29, 1
    s_cselect_b64 s[44:45], s[16:17], s[18:19]
    s_cmp_lt_u32 s29, 16
    s_cselect_b64 s[44:45], s[10:11], s[44:45]
    s_mov_b64 s[40:41], s[4:5]
    buffer_load_dwordx4 v[8:11], v121, s[40:43], s62 offen
    buffer_load_dwordx4 v122, s[44:47], s61 offen nt lds
    s_add_u32 m0, m0, s60
    s_add_u32 s61, s61, s59
    buffer_load_dwordx4 v122, s[44:47], s61 offen nt lds
    s_add_u32 m0, m0, s60
    s_add_u32 s61, s61, s59
    buffer_load_dwordx4 v122, s[44:47], s61 offen nt lds
    s_add_u32 m0, m0, s60
    s_add_u32 s61, s61, s59
    buffer_load_dwordx4 v122, s[44:47], s61 offen nt lds
    s_add_u32 m0, m0, s60
    s_add_u32 s61, s61, s59
    buffer_load_dwordx4 v122, s[44:47], s61 offen nt lds
    s_add_u32 m0, m0, s60
    s_add_u32 s61, s61, s59
    buffer_load_dwordx4 v122, s[44:47], s61 offen nt lds
    s_add_u32 m0, m0, s60
    s_add_u32 s61, s61, s59
    buffer_load_dwordx4 v122, s[44:47], s61 offen nt lds
    s_branch L_compute
L_probe:
    s_load_dword s64, s[26:27], 131072
    s_load_dword s65, s[26:27], 139264
    s_waitcnt lgkmcnt(1)
    s_lshl_b32 s99, s28, 2
    s_mul_i32 s100, s28, 3
    s_add_u32 s100, s100, 4
    s_min_u32 s99, s99, s100
    s_lshl_b32 s99, s99, 6
    s_cmp_lt_u32 s28, 4
    s_cselect_b32 s101, 32, 24
    s_mul_i32 s100, s101, s31
    s_add_u32 s100, s100, s99
    s_getreg_b32 s97, hwreg(HW_REG_IB_STS, 8, 4)
    s_branch L_helper
L_loader:
    v_xor_b32 v12, 128, v8
    v_xor_b32 v13, 160, v8
    v_xor_b32 v14, 192, v8
    v_xor_b32 v15, 224, v8
    s_setprio 3
    s_mov_b32 m0, 69632
    s_add_u32 s64, s64, s63
    s_and_b32 s64, s64, s66
    buffer_load_dwordx4 v12, s[40:43], s64 offen nt lds
    s_add_u32 m0, m0, s63
    s_add_u32 s64, s64, s63
    s_and_b32 s64, s64, s66
    buffer_load_dwordx4 v13, s[40:43], s64 offen nt lds
    s_add_u32 m0, m0, s63
    s_add_u32 s64, s64, s63
    s_and_b32 s64, s64, s66
    buffer_load_dwordx4 v14, s[40:43], s64 offen nt lds
    s_add_u32 m0, m0, s63
    s_add_u32 s64, s64, s63
    s_and_b32 s64, s64, s66
    buffer_load_dwordx4 v15, s[40:43], s64 offen nt lds
    s_lshl_b32 s99, s28, 2
    s_mul_i32 s100, s28, 3
    s_add_u32 s100, s100, 4
    s_min_u32 s99, s99, s100
    s_lshl_b32 s99, s99, 6
    s_cmp_lt_u32 s28, 4
    s_cselect_b32 s101, 32, 24
    s_mul_i32 s100, s101, s31
    s_add_u32 s100, s100, s99
    v_lshlrev_b32 v3, 2, v0
    v_add_u32 v3, 159744, v3
    v_mov_b32 v4, 159744
    v_lshlrev_b32 v6, 1, v1
    v_xor_b32 v6, v6, v2
    v_lshlrev_b32 v6, 4, v6
    v_lshl_add_u32 v16, v1, 9, v6
    v_xor_b32 v17, 64, v16
    v_xor_b32 v18, 128, v16
    v_xor_b32 v19, 192, v16
    s_movk_i32 s58, 1171
    s_movk_i32 s59, 896
    v_add_u32 v1, 0, v0
    v_mul_u32_u24 v2, s58, v1
    v_lshrrev_b32 v2, 16, v2
    v_mul_u32_u24 v6, 56, v2
    v_sub_u32 v1, v1, v6
    v_bfe_u32 v6, v2, 2, 1
    v_lshlrev_b32 v6, 1, v6
    v_xor_b32 v1, v1, v6
    v_xor_b32 v6, 4, v1
    v_mul_u32_u24 v2, s59, v2
    v_add_u32 v2, 128, v2
    v_lshl_add_u32 v20, v1, 4, v2
    v_lshl_add_u32 v28, v6, 4, v2
    v_add_u32 v1, 64, v0
    v_mul_u32_u24 v2, s58, v1
    v_lshrrev_b32 v2, 16, v2
    v_mul_u32_u24 v6, 56, v2
    v_sub_u32 v1, v1, v6
    v_bfe_u32 v6, v2, 2, 1
    v_lshlrev_b32 v6, 1, v6
    v_xor_b32 v1, v1, v6
    v_xor_b32 v6, 4, v1
    v_mul_u32_u24 v2, s59, v2
    v_add_u32 v2, 4294966400, v2
    v_lshl_add_u32 v21, v1, 4, v2
    v_lshl_add_u32 v29, v6, 4, v2
    v_add_u32 v1, 128, v0
    v_mul_u32_u24 v2, s58, v1
    v_lshrrev_b32 v2, 16, v2
    v_mul_u32_u24 v6, 56, v2
    v_sub_u32 v1, v1, v6
    v_bfe_u32 v6, v2, 2, 1
    v_lshlrev_b32 v6, 1, v6
    v_xor_b32 v1, v1, v6
    v_xor_b32 v6, 4, v1
    v_mul_u32_u24 v2, s59, v2
    v_add_u32 v2, 4294965376, v2
    v_lshl_add_u32 v22, v1, 4, v2
    v_lshl_add_u32 v30, v6, 4, v2
    v_add_u32 v1, 192, v0
    v_mul_u32_u24 v2, s58, v1
    v_lshrrev_b32 v2, 16, v2
    v_mul_u32_u24 v6, 56, v2
    v_sub_u32 v1, v1, v6
    v_bfe_u32 v6, v2, 2, 1
    v_lshlrev_b32 v6, 1, v6
    v_xor_b32 v1, v1, v6
    v_xor_b32 v6, 4, v1
    v_mul_u32_u24 v2, s59, v2
    v_add_u32 v2, 4294964352, v2
    v_lshl_add_u32 v23, v1, 4, v2
    v_lshl_add_u32 v31, v6, 4, v2
    v_add_u32 v1, 256, v0
    v_mul_u32_u24 v2, s58, v1
    v_lshrrev_b32 v2, 16, v2
    v_mul_u32_u24 v6, 56, v2
    v_sub_u32 v1, v1, v6
    v_bfe_u32 v6, v2, 2, 1
    v_lshlrev_b32 v6, 1, v6
    v_xor_b32 v1, v1, v6
    v_xor_b32 v6, 4, v1
    v_mul_u32_u24 v2, s59, v2
    v_add_u32 v2, 4294963328, v2
    v_lshl_add_u32 v24, v1, 4, v2
    v_lshl_add_u32 v32, v6, 4, v2
    v_add_u32 v1, 320, v0
    v_mul_u32_u24 v2, s58, v1
    v_lshrrev_b32 v2, 16, v2
    v_mul_u32_u24 v6, 56, v2
    v_sub_u32 v1, v1, v6
    v_bfe_u32 v6, v2, 2, 1
    v_lshlrev_b32 v6, 1, v6
    v_xor_b32 v1, v1, v6
    v_xor_b32 v6, 4, v1
    v_mul_u32_u24 v2, s59, v2
    v_add_u32 v2, 4294962304, v2
    v_lshl_add_u32 v25, v1, 4, v2
    v_lshl_add_u32 v33, v6, 4, v2
    v_add_u32 v1, 384, v0
    v_mul_u32_u24 v2, s58, v1
    v_lshrrev_b32 v2, 16, v2
    v_mul_u32_u24 v6, 56, v2
    v_sub_u32 v1, v1, v6
    v_bfe_u32 v6, v2, 2, 1
    v_lshlrev_b32 v6, 1, v6
    v_xor_b32 v1, v1, v6
    v_xor_b32 v6, 4, v1
    v_mul_u32_u24 v2, s59, v2
    v_add_u32 v2, 4294961280, v2
    v_lshl_add_u32 v26, v1, 4, v2
    v_lshl_add_u32 v34, v6, 4, v2
    s_sub_u32 s48, s12, 128
    s_subb_u32 s49, s13, 0
    s_mov_b32 s50, 3670144
    s_mov_b32 s51, 0x20000
    s_lshl_b32 s58, s28, 9
    s_lshl_b32 s59, s31, 5
    s_add_u32 s58, s58, s59
    s_mul_i32 s65, s58, 896
    s_add_u32 s68, s65, 229376
    s_add_u32 s44, s8, s61
    s_addc_u32 s45, s9, 0
    s_mov_b32 s46, 65536
    s_mov_b32 s47, 0x20000
    s_sub_u32 s52, s20, 128
    s_subb_u32 s53, s21, 0
    s_mov_b32 s54, 0
    s_mov_b32 s55, 0x20000
    s_add_u32 s54, s100, s101
    s_mul_i32 s54, s54, 896
    s_add_u32 s54, s54, 128
    s_mul_i32 s69, s100, 896
    s_barrier
    s_mov_b32 m0, 36864
    s_add_u32 s67, s65, 0
    buffer_load_dwordx4 v20, s[48:51], s67 offen offset:0 nt lds
    buffer_load_dwordx4 v21, s[48:51], s67 offen offset:1024 nt lds
    buffer_load_dwordx4 v22, s[48:51], s67 offen offset:2048 nt lds
    buffer_load_dwordx4 v23, s[48:51], s67 offen offset:3072 nt lds
    s_mov_b32 m0, 73728
    s_add_u32 s64, s64, s63
    s_and_b32 s64, s64, s66
    buffer_load_dwordx4 v8, s[40:43], s64 offen nt lds
    s_add_u32 m0, m0, s63
    s_add_u32 s64, s64, s63
    s_and_b32 s64, s64, s66
    buffer_load_dwordx4 v9, s[40:43], s64 offen nt lds
    s_add_u32 m0, m0, s63
    s_add_u32 s64, s64, s63
    s_and_b32 s64, s64, s66
    buffer_load_dwordx4 v10, s[40:43], s64 offen nt lds
    s_add_u32 m0, m0, s63
    s_add_u32 s64, s64, s63
    s_and_b32 s64, s64, s66
    buffer_load_dwordx4 v11, s[40:43], s64 offen nt lds
    s_mov_b32 m0, 40960
    s_add_u32 s67, s65, 4096
    buffer_load_dwordx4 v24, s[48:51], s67 offen offset:0 nt lds
    buffer_load_dwordx4 v25, s[48:51], s67 offen offset:1024 nt lds
    buffer_load_dwordx4 v26, s[48:51], s67 offen offset:2048 nt lds
    s_mov_b32 m0, 77824
    s_add_u32 s64, s64, s63
    s_and_b32 s64, s64, s66
    buffer_load_dwordx4 v12, s[40:43], s64 offen nt lds
    s_add_u32 m0, m0, s63
    s_add_u32 s64, s64, s63
    s_and_b32 s64, s64, s66
    buffer_load_dwordx4 v13, s[40:43], s64 offen nt lds
    s_add_u32 m0, m0, s63
    s_add_u32 s64, s64, s63
    s_and_b32 s64, s64, s66
    buffer_load_dwordx4 v14, s[40:43], s64 offen nt lds
    s_add_u32 m0, m0, s63
    s_add_u32 s64, s64, s63
    s_and_b32 s64, s64, s66
    buffer_load_dwordx4 v15, s[40:43], s64 offen nt lds
    s_mov_b32 m0, 44032
    s_add_u32 s67, s65, 7168
    buffer_load_dwordx4 v20, s[48:51], s67 offen offset:0 nt lds
    buffer_load_dwordx4 v21, s[48:51], s67 offen offset:1024 nt lds
    buffer_load_dwordx4 v22, s[48:51], s67 offen offset:2048 nt lds
    buffer_load_dwordx4 v23, s[48:51], s67 offen offset:3072 nt lds
    s_mov_b32 m0, 81920
    s_add_u32 s64, s64, s63
    s_and_b32 s64, s64, s66
    buffer_load_dwordx4 v8, s[40:43], s64 offen nt lds
    s_add_u32 m0, m0, s63
    s_add_u32 s64, s64, s63
    s_and_b32 s64, s64, s66
    buffer_load_dwordx4 v9, s[40:43], s64 offen nt lds
    s_add_u32 m0, m0, s63
    s_add_u32 s64, s64, s63
    s_and_b32 s64, s64, s66
    buffer_load_dwordx4 v10, s[40:43], s64 offen nt lds
    s_add_u32 m0, m0, s63
    s_add_u32 s64, s64, s63
    s_and_b32 s64, s64, s66
    buffer_load_dwordx4 v11, s[40:43], s64 offen nt lds
    s_mov_b32 m0, 48128
    s_add_u32 s67, s65, 11264
    buffer_load_dwordx4 v24, s[48:51], s67 offen offset:0 nt lds
    buffer_load_dwordx4 v25, s[48:51], s67 offen offset:1024 nt lds
    buffer_load_dwordx4 v26, s[48:51], s67 offen offset:2048 nt lds
    s_mov_b32 m0, 86016
    s_add_u32 s64, s64, s63
    s_and_b32 s64, s64, s66
    buffer_load_dwordx4 v12, s[40:43], s64 offen nt lds
    s_add_u32 m0, m0, s63
    s_add_u32 s64, s64, s63
    s_and_b32 s64, s64, s66
    buffer_load_dwordx4 v13, s[40:43], s64 offen nt lds
    s_add_u32 m0, m0, s63
    s_add_u32 s64, s64, s63
    s_and_b32 s64, s64, s66
    buffer_load_dwordx4 v14, s[40:43], s64 offen nt lds
    s_add_u32 m0, m0, s63
    s_add_u32 s64, s64, s63
    s_and_b32 s64, s64, s66
    buffer_load_dwordx4 v15, s[40:43], s64 offen nt lds
    s_mov_b32 m0, 51200
    s_add_u32 s67, s65, 14336
    buffer_load_dwordx4 v28, s[48:51], s67 offen offset:0 nt lds
    buffer_load_dwordx4 v29, s[48:51], s67 offen offset:1024 nt lds
    buffer_load_dwordx4 v30, s[48:51], s67 offen offset:2048 nt lds
    buffer_load_dwordx4 v31, s[48:51], s67 offen offset:3072 nt lds
    s_mov_b32 m0, 90112
    s_add_u32 s64, s64, s63
    s_and_b32 s64, s64, s66
    buffer_load_dwordx4 v8, s[40:43], s64 offen nt lds
    s_add_u32 m0, m0, s63
    s_add_u32 s64, s64, s63
    s_and_b32 s64, s64, s66
    buffer_load_dwordx4 v9, s[40:43], s64 offen nt lds
    s_add_u32 m0, m0, s63
    s_add_u32 s64, s64, s63
    s_and_b32 s64, s64, s66
    buffer_load_dwordx4 v10, s[40:43], s64 offen nt lds
    s_waitcnt vmcnt(44)
    s_add_u32 m0, m0, s63
    s_add_u32 s64, s64, s63
    s_and_b32 s64, s64, s66
    buffer_load_dwordx4 v11, s[40:43], s64 offen nt lds
    s_waitcnt vmcnt(44)
    s_mov_b32 m0, 55296
    s_add_u32 s67, s65, 18432
    buffer_load_dwordx4 v32, s[48:51], s67 offen offset:0 nt lds
    s_waitcnt vmcnt(44)
    buffer_load_dwordx4 v33, s[48:51], s67 offen offset:1024 nt lds
    s_waitcnt vmcnt(44)
    buffer_load_dwordx4 v34, s[48:51], s67 offen offset:2048 nt lds
    s_waitcnt vmcnt(44)
    s_mov_b32 m0, 94208
    s_add_u32 s64, s64, s63
    s_and_b32 s64, s64, s66
    buffer_load_dwordx4 v12, s[40:43], s64 offen nt lds
    s_waitcnt vmcnt(44)
    s_add_u32 m0, m0, s63
    s_add_u32 s64, s64, s63
    s_and_b32 s64, s64, s66
    buffer_load_dwordx4 v13, s[40:43], s64 offen nt lds
    s_waitcnt vmcnt(44)
    s_add_u32 m0, m0, s63
    s_add_u32 s64, s64, s63
    s_and_b32 s64, s64, s66
    buffer_load_dwordx4 v14, s[40:43], s64 offen nt lds
    s_waitcnt vmcnt(44)
    s_add_u32 m0, m0, s63
    s_add_u32 s64, s64, s63
    s_and_b32 s64, s64, s66
    buffer_load_dwordx4 v15, s[40:43], s64 offen nt lds
    s_waitcnt vmcnt(44)
    s_mov_b32 m0, 58368
    s_add_u32 s67, s65, 21504
    buffer_load_dwordx4 v28, s[48:51], s67 offen offset:0 nt lds
    s_waitcnt vmcnt(44)
    buffer_load_dwordx4 v29, s[48:51], s67 offen offset:1024 nt lds
    s_waitcnt vmcnt(44)
    buffer_load_dwordx4 v30, s[48:51], s67 offen offset:2048 nt lds
    s_waitcnt vmcnt(44)
    buffer_load_dwordx4 v31, s[48:51], s67 offen offset:3072 nt lds
    s_waitcnt vmcnt(44)
    s_mov_b32 m0, 98304
    s_add_u32 s64, s64, s63
    s_and_b32 s64, s64, s66
    buffer_load_dwordx4 v8, s[40:43], s64 offen nt lds
    s_waitcnt vmcnt(44)
    s_add_u32 m0, m0, s63
    s_add_u32 s64, s64, s63
    s_and_b32 s64, s64, s66
    buffer_load_dwordx4 v9, s[40:43], s64 offen nt lds
    s_waitcnt vmcnt(44)
    s_add_u32 m0, m0, s63
    s_add_u32 s64, s64, s63
    s_and_b32 s64, s64, s66
    buffer_load_dwordx4 v10, s[40:43], s64 offen nt lds
    s_waitcnt vmcnt(44)
    s_add_u32 m0, m0, s63
    s_add_u32 s64, s64, s63
    s_and_b32 s64, s64, s66
    buffer_load_dwordx4 v11, s[40:43], s64 offen nt lds
    s_waitcnt vmcnt(44)
    s_mov_b32 m0, 62464
    s_add_u32 s67, s65, 25600
    buffer_load_dwordx4 v32, s[48:51], s67 offen offset:0 nt lds
    s_waitcnt vmcnt(44)
    buffer_load_dwordx4 v33, s[48:51], s67 offen offset:1024 nt lds
    s_waitcnt vmcnt(44)
    buffer_load_dwordx4 v34, s[48:51], s67 offen offset:2048 nt lds
    s_waitcnt vmcnt(44)
    s_mov_b32 m0, 102400
    s_add_u32 s64, s64, s63
    s_and_b32 s64, s64, s66
    buffer_load_dwordx4 v12, s[40:43], s64 offen nt lds
    s_waitcnt vmcnt(44)
    s_add_u32 m0, m0, s63
    s_add_u32 s64, s64, s63
    s_and_b32 s64, s64, s66
    buffer_load_dwordx4 v13, s[40:43], s64 offen nt lds
    s_waitcnt vmcnt(44)
    s_add_u32 m0, m0, s63
    s_add_u32 s64, s64, s63
    s_and_b32 s64, s64, s66
    buffer_load_dwordx4 v14, s[40:43], s64 offen nt lds
    s_waitcnt vmcnt(44)
    s_add_u32 m0, m0, s63
    s_add_u32 s64, s64, s63
    s_and_b32 s64, s64, s66
    buffer_load_dwordx4 v15, s[40:43], s64 offen nt lds
    s_waitcnt vmcnt(44)
L_spin_1:
    ds_read_b32 v1, v4 offset:256
    s_waitcnt lgkmcnt(0)
    v_readfirstlane_b32 s56, v1
    s_nop 0
    s_cmp_ge_u32 s56, 4
    s_cbranch_scc1 L_spind_2
    s_sleep 1
    s_branch L_spin_1
L_spind_2:
    s_mov_b32 m0, 131072
    s_add_u32 s67, s69, 0
    buffer_load_dwordx4 v20, s[52:55], s67 offen offset:0 nt lds
    s_waitcnt vmcnt(44)
    buffer_load_dwordx4 v21, s[52:55], s67 offen offset:1024 nt lds
    s_waitcnt vmcnt(44)
    buffer_load_dwordx4 v22, s[52:55], s67 offen offset:2048 nt lds
    s_waitcnt vmcnt(44)
    buffer_load_dwordx4 v23, s[52:55], s67 offen offset:3072 nt lds
    s_waitcnt vmcnt(44)
    s_mov_b32 m0, 106496
    s_add_u32 s64, s64, s63
    s_and_b32 s64, s64, s66
    buffer_load_dwordx4 v8, s[40:43], s64 offen nt lds
    s_waitcnt vmcnt(44)
    s_add_u32 m0, m0, s63
    s_add_u32 s64, s64, s63
    s_and_b32 s64, s64, s66
    buffer_load_dwordx4 v9, s[40:43], s64 offen nt lds
    s_waitcnt vmcnt(44)
    s_add_u32 m0, m0, s63
    s_add_u32 s64, s64, s63
    s_and_b32 s64, s64, s66
    buffer_load_dwordx4 v10, s[40:43], s64 offen nt lds
    s_waitcnt vmcnt(44)
    s_add_u32 m0, m0, s63
    s_add_u32 s64, s64, s63
    s_and_b32 s64, s64, s66
    buffer_load_dwordx4 v11, s[40:43], s64 offen nt lds
    s_waitcnt vmcnt(44)
    s_mov_b32 m0, 135168
    s_add_u32 s67, s69, 4096
    buffer_load_dwordx4 v24, s[52:55], s67 offen offset:0 nt lds
    s_waitcnt vmcnt(44)
    buffer_load_dwordx4 v25, s[52:55], s67 offen offset:1024 nt lds
    s_waitcnt vmcnt(44)
    buffer_load_dwordx4 v26, s[52:55], s67 offen offset:2048 nt lds
    s_waitcnt vmcnt(44)
    s_mov_b32 m0, 110592
    s_add_u32 s64, s64, s63
    s_and_b32 s64, s64, s66
    buffer_load_dwordx4 v12, s[40:43], s64 offen nt lds
    s_waitcnt vmcnt(44)
    s_add_u32 m0, m0, s63
    s_add_u32 s64, s64, s63
    s_and_b32 s64, s64, s66
    buffer_load_dwordx4 v13, s[40:43], s64 offen nt lds
    s_waitcnt vmcnt(44)
    s_add_u32 m0, m0, s63
    s_add_u32 s64, s64, s63
    s_and_b32 s64, s64, s66
    buffer_load_dwordx4 v14, s[40:43], s64 offen nt lds
    s_waitcnt vmcnt(44)
    s_add_u32 m0, m0, s63
    s_add_u32 s64, s64, s63
    s_and_b32 s64, s64, s66
    buffer_load_dwordx4 v15, s[40:43], s64 offen nt lds
    s_waitcnt vmcnt(44)
    s_mov_b32 m0, 138240
    s_add_u32 s67, s69, 7168
    buffer_load_dwordx4 v20, s[52:55], s67 offen offset:0 nt lds
    s_waitcnt vmcnt(44)
    buffer_load_dwordx4 v21, s[52:55], s67 offen offset:1024 nt lds
    s_waitcnt vmcnt(44)
    buffer_load_dwordx4 v22, s[52:55], s67 offen offset:2048 nt lds
    s_waitcnt vmcnt(44)
    buffer_load_dwordx4 v23, s[52:55], s67 offen offset:3072 nt lds
    s_waitcnt vmcnt(44)
    s_mov_b32 m0, 114688
    s_add_u32 s64, s64, s63
    s_and_b32 s64, s64, s66
    buffer_load_dwordx4 v8, s[40:43], s64 offen nt lds
    s_waitcnt vmcnt(44)
    s_add_u32 m0, m0, s63
    s_add_u32 s64, s64, s63
    s_and_b32 s64, s64, s66
    buffer_load_dwordx4 v9, s[40:43], s64 offen nt lds
    s_waitcnt vmcnt(44)
    s_add_u32 m0, m0, s63
    s_add_u32 s64, s64, s63
    s_and_b32 s64, s64, s66
    buffer_load_dwordx4 v10, s[40:43], s64 offen nt lds
    s_waitcnt vmcnt(44)
    s_add_u32 m0, m0, s63
    s_add_u32 s64, s64, s63
    s_and_b32 s64, s64, s66
    buffer_load_dwordx4 v11, s[40:43], s64 offen nt lds
    s_waitcnt vmcnt(44)
    s_mov_b32 m0, 142336
    s_add_u32 s67, s69, 11264
    buffer_load_dwordx4 v24, s[52:55], s67 offen offset:0 nt lds
    s_waitcnt vmcnt(44)
    buffer_load_dwordx4 v25, s[52:55], s67 offen offset:1024 nt lds
    s_waitcnt vmcnt(44)
    buffer_load_dwordx4 v26, s[52:55], s67 offen offset:2048 nt lds
    s_waitcnt vmcnt(44)
    s_mov_b32 m0, 118784
    s_add_u32 s64, s64, s63
    s_and_b32 s64, s64, s66
    buffer_load_dwordx4 v12, s[40:43], s64 offen nt lds
    s_waitcnt vmcnt(44)
    s_add_u32 m0, m0, s63
    s_add_u32 s64, s64, s63
    s_and_b32 s64, s64, s66
    buffer_load_dwordx4 v13, s[40:43], s64 offen nt lds
    s_waitcnt vmcnt(44)
    s_add_u32 m0, m0, s63
    s_add_u32 s64, s64, s63
    s_and_b32 s64, s64, s66
    buffer_load_dwordx4 v14, s[40:43], s64 offen nt lds
    s_waitcnt vmcnt(44)
    s_add_u32 m0, m0, s63
    s_add_u32 s64, s64, s63
    s_and_b32 s64, s64, s66
    buffer_load_dwordx4 v15, s[40:43], s64 offen nt lds
    s_waitcnt vmcnt(44)
    s_mov_b32 m0, 145408
    s_add_u32 s67, s69, 14336
    buffer_load_dwordx4 v28, s[52:55], s67 offen offset:0 nt lds
    s_waitcnt vmcnt(44)
    buffer_load_dwordx4 v29, s[52:55], s67 offen offset:1024 nt lds
    s_waitcnt vmcnt(44)
    buffer_load_dwordx4 v30, s[52:55], s67 offen offset:2048 nt lds
    s_waitcnt vmcnt(44)
    buffer_load_dwordx4 v31, s[52:55], s67 offen offset:3072 nt lds
    s_waitcnt vmcnt(44)
    s_mov_b32 m0, 122880
    s_add_u32 s64, s64, s63
    s_and_b32 s64, s64, s66
    buffer_load_dwordx4 v8, s[40:43], s64 offen nt lds
    s_waitcnt vmcnt(44)
    s_add_u32 m0, m0, s63
    s_add_u32 s64, s64, s63
    s_and_b32 s64, s64, s66
    buffer_load_dwordx4 v9, s[40:43], s64 offen nt lds
    s_waitcnt vmcnt(44)
    s_add_u32 m0, m0, s63
    s_add_u32 s64, s64, s63
    s_and_b32 s64, s64, s66
    buffer_load_dwordx4 v10, s[40:43], s64 offen nt lds
    s_waitcnt vmcnt(44)
    s_add_u32 m0, m0, s63
    s_add_u32 s64, s64, s63
    s_and_b32 s64, s64, s66
    buffer_load_dwordx4 v11, s[40:43], s64 offen nt lds
    s_waitcnt vmcnt(44)
    s_mov_b32 m0, 149504
    s_add_u32 s67, s69, 18432
    buffer_load_dwordx4 v32, s[52:55], s67 offen offset:0 nt lds
    s_waitcnt vmcnt(44)
    buffer_load_dwordx4 v33, s[52:55], s67 offen offset:1024 nt lds
    s_waitcnt vmcnt(44)
    v_mov_b32 v5, 1
    ds_write_b32 v3, v5
    buffer_load_dwordx4 v34, s[52:55], s67 offen offset:2048 nt lds
    s_waitcnt vmcnt(44)
    s_mov_b32 m0, 126976
    s_add_u32 s64, s64, s63
    s_and_b32 s64, s64, s66
    buffer_load_dwordx4 v12, s[40:43], s64 offen nt lds
    s_waitcnt vmcnt(44)
    s_add_u32 m0, m0, s63
    s_add_u32 s64, s64, s63
    s_and_b32 s64, s64, s66
    buffer_load_dwordx4 v13, s[40:43], s64 offen nt lds
    s_waitcnt vmcnt(44)
    s_add_u32 m0, m0, s63
    s_add_u32 s64, s64, s63
    s_and_b32 s64, s64, s66
    buffer_load_dwordx4 v14, s[40:43], s64 offen nt lds
    s_waitcnt vmcnt(44)
    s_add_u32 m0, m0, s63
    s_add_u32 s64, s64, s63
    s_and_b32 s64, s64, s66
    buffer_load_dwordx4 v15, s[40:43], s64 offen nt lds
    s_waitcnt vmcnt(44)
    s_mov_b32 m0, 152576
    s_add_u32 s67, s69, 21504
    buffer_load_dwordx4 v28, s[52:55], s67 offen offset:0 nt lds
    s_waitcnt vmcnt(44)
    buffer_load_dwordx4 v29, s[52:55], s67 offen offset:1024 nt lds
    s_waitcnt vmcnt(44)
    buffer_load_dwordx4 v30, s[52:55], s67 offen offset:2048 nt lds
    s_waitcnt vmcnt(44)
    buffer_load_dwordx4 v31, s[52:55], s67 offen offset:3072 nt lds
    s_waitcnt vmcnt(44)
    s_mov_b32 m0, 156672
    s_add_u32 s67, s69, 25600
    buffer_load_dwordx4 v32, s[52:55], s67 offen offset:0 nt lds
    s_waitcnt vmcnt(44)
    buffer_load_dwordx4 v33, s[52:55], s67 offen offset:1024 nt lds
    s_waitcnt vmcnt(44)
    buffer_load_dwordx4 v34, s[52:55], s67 offen offset:2048 nt lds
    s_waitcnt vmcnt(44)
    s_mov_b32 m0, 0
    s_add_u32 s64, s64, s63
    s_and_b32 s64, s64, s66
    buffer_load_dwordx4 v16, s[44:47], s64 offen nt lds
    s_waitcnt vmcnt(32)
    s_add_u32 m0, m0, s63
    s_add_u32 s64, s64, s63
    s_and_b32 s64, s64, s66
    buffer_load_dwordx4 v17, s[44:47], s64 offen nt lds
    s_waitcnt vmcnt(32)
    s_add_u32 m0, m0, s63
    s_add_u32 s64, s64, s63
    s_and_b32 s64, s64, s66
    buffer_load_dwordx4 v18, s[44:47], s64 offen nt lds
    s_waitcnt vmcnt(32)
    s_add_u32 m0, m0, s63
    s_add_u32 s64, s64, s63
    s_and_b32 s64, s64, s66
    buffer_load_dwordx4 v19, s[44:47], s64 offen nt lds
    s_waitcnt vmcnt(32)
    s_mov_b32 m0, 4096
    s_add_u32 s64, s64, s63
    s_and_b32 s64, s64, s66
    buffer_load_dwordx4 v16, s[44:47], s64 offen nt lds
    s_waitcnt vmcnt(32)
    s_add_u32 m0, m0, s63
    s_add_u32 s64, s64, s63
    s_and_b32 s64, s64, s66
    buffer_load_dwordx4 v17, s[44:47], s64 offen nt lds
    s_waitcnt vmcnt(32)
    s_add_u32 m0, m0, s63
    s_add_u32 s64, s64, s63
    s_and_b32 s64, s64, s66
    buffer_load_dwordx4 v18, s[44:47], s64 offen nt lds
    s_waitcnt vmcnt(32)
    s_add_u32 m0, m0, s63
    s_add_u32 s64, s64, s63
    s_and_b32 s64, s64, s66
    buffer_load_dwordx4 v19, s[44:47], s64 offen nt lds
    s_waitcnt vmcnt(32)
    s_mov_b32 m0, 8192
    s_add_u32 s64, s64, s63
    s_and_b32 s64, s64, s66
    buffer_load_dwordx4 v16, s[44:47], s64 offen nt lds
    s_waitcnt vmcnt(32)
    s_add_u32 m0, m0, s63
    s_add_u32 s64, s64, s63
    s_and_b32 s64, s64, s66
    buffer_load_dwordx4 v17, s[44:47], s64 offen nt lds
    s_waitcnt vmcnt(32)
    s_add_u32 m0, m0, s63
    s_add_u32 s64, s64, s63
    s_and_b32 s64, s64, s66
    buffer_load_dwordx4 v18, s[44:47], s64 offen nt lds
    s_waitcnt vmcnt(32)
    s_add_u32 m0, m0, s63
    s_add_u32 s64, s64, s63
    s_and_b32 s64, s64, s66
    buffer_load_dwordx4 v19, s[44:47], s64 offen nt lds
    s_waitcnt vmcnt(32)
    s_mov_b32 m0, 12288
    s_add_u32 s64, s64, s63
    s_and_b32 s64, s64, s66
    buffer_load_dwordx4 v16, s[44:47], s64 offen nt lds
    s_waitcnt vmcnt(32)
    s_add_u32 m0, m0, s63
    s_add_u32 s64, s64, s63
    s_and_b32 s64, s64, s66
    buffer_load_dwordx4 v17, s[44:47], s64 offen nt lds
    s_waitcnt vmcnt(32)
    s_add_u32 m0, m0, s63
    s_add_u32 s64, s64, s63
    s_and_b32 s64, s64, s66
    buffer_load_dwordx4 v18, s[44:47], s64 offen nt lds
    s_waitcnt vmcnt(32)
    s_add_u32 m0, m0, s63
    s_add_u32 s64, s64, s63
    s_and_b32 s64, s64, s66
    buffer_load_dwordx4 v19, s[44:47], s64 offen nt lds
    s_waitcnt vmcnt(32)
    s_mov_b32 m0, 16384
    s_add_u32 s64, s64, s63
    s_and_b32 s64, s64, s66
    buffer_load_dwordx4 v16, s[44:47], s64 offen nt lds
    s_waitcnt vmcnt(32)
    s_add_u32 m0, m0, s63
    s_add_u32 s64, s64, s63
    s_and_b32 s64, s64, s66
    buffer_load_dwordx4 v17, s[44:47], s64 offen nt lds
    s_waitcnt vmcnt(32)
    s_add_u32 m0, m0, s63
    s_add_u32 s64, s64, s63
    s_and_b32 s64, s64, s66
    buffer_load_dwordx4 v18, s[44:47], s64 offen nt lds
    s_waitcnt vmcnt(32)
    s_add_u32 m0, m0, s63
    s_add_u32 s64, s64, s63
    s_and_b32 s64, s64, s66
    buffer_load_dwordx4 v19, s[44:47], s64 offen nt lds
    s_waitcnt vmcnt(32)
    s_mov_b32 m0, 20480
    s_add_u32 s64, s64, s63
    s_and_b32 s64, s64, s66
    buffer_load_dwordx4 v16, s[44:47], s64 offen nt lds
    s_waitcnt vmcnt(32)
    s_add_u32 m0, m0, s63
    s_add_u32 s64, s64, s63
    s_and_b32 s64, s64, s66
    buffer_load_dwordx4 v17, s[44:47], s64 offen nt lds
    s_waitcnt vmcnt(32)
    s_add_u32 m0, m0, s63
    s_add_u32 s64, s64, s63
    s_and_b32 s64, s64, s66
    buffer_load_dwordx4 v18, s[44:47], s64 offen nt lds
    s_waitcnt vmcnt(32)
    s_add_u32 m0, m0, s63
    s_add_u32 s64, s64, s63
    s_and_b32 s64, s64, s66
    buffer_load_dwordx4 v19, s[44:47], s64 offen nt lds
    s_waitcnt vmcnt(32)
    s_mov_b32 m0, 24576
    s_add_u32 s64, s64, s63
    s_and_b32 s64, s64, s66
    buffer_load_dwordx4 v16, s[44:47], s64 offen nt lds
    s_waitcnt vmcnt(32)
    s_add_u32 m0, m0, s63
    s_add_u32 s64, s64, s63
    s_and_b32 s64, s64, s66
    buffer_load_dwordx4 v17, s[44:47], s64 offen nt lds
    s_waitcnt vmcnt(32)
    s_add_u32 m0, m0, s63
    s_add_u32 s64, s64, s63
    s_and_b32 s64, s64, s66
    buffer_load_dwordx4 v18, s[44:47], s64 offen nt lds
    s_waitcnt vmcnt(32)
    s_add_u32 m0, m0, s63
    s_add_u32 s64, s64, s63
    s_and_b32 s64, s64, s66
    buffer_load_dwordx4 v19, s[44:47], s64 offen nt lds
    s_waitcnt vmcnt(32)
    s_mov_b32 m0, 28672
    s_add_u32 s64, s64, s63
    s_and_b32 s64, s64, s66
    buffer_load_dwordx4 v16, s[44:47], s64 offen nt lds
    s_waitcnt vmcnt(32)
    s_add_u32 m0, m0, s63
    s_add_u32 s64, s64, s63
    s_and_b32 s64, s64, s66
    buffer_load_dwordx4 v17, s[44:47], s64 offen nt lds
    s_waitcnt vmcnt(32)
    s_add_u32 m0, m0, s63
    s_add_u32 s64, s64, s63
    s_and_b32 s64, s64, s66
    buffer_load_dwordx4 v18, s[44:47], s64 offen nt lds
    s_waitcnt vmcnt(32)
    s_add_u32 m0, m0, s63
    s_add_u32 s64, s64, s63
    s_and_b32 s64, s64, s66
    buffer_load_dwordx4 v19, s[44:47], s64 offen nt lds
    s_waitcnt vmcnt(32)
    v_mov_b32 v5, 2
    ds_write_b32 v3, v5
    s_mov_b32 m0, 32768
    s_add_u32 s64, s64, s63
    s_and_b32 s64, s64, s66
    buffer_load_dwordx4 v16, s[44:47], s64 offen nt lds
    s_waitcnt vmcnt(32)
    s_add_u32 m0, m0, s63
    s_add_u32 s64, s64, s63
    s_and_b32 s64, s64, s66
    buffer_load_dwordx4 v17, s[44:47], s64 offen nt lds
    s_waitcnt vmcnt(32)
    s_add_u32 m0, m0, s63
    s_add_u32 s64, s64, s63
    s_and_b32 s64, s64, s66
    buffer_load_dwordx4 v18, s[44:47], s64 offen nt lds
    s_waitcnt vmcnt(32)
    s_add_u32 m0, m0, s63
    s_add_u32 s64, s64, s63
    s_and_b32 s64, s64, s66
    buffer_load_dwordx4 v19, s[44:47], s64 offen nt lds
    s_waitcnt vmcnt(32)
L_spin_3:
    ds_read_b32 v1, v4 offset:276
    s_waitcnt lgkmcnt(0)
    v_readfirstlane_b32 s56, v1
    s_nop 0
    s_cmp_ge_u32 s56, 4
    s_cbranch_scc1 L_spind_4
    s_sleep 1
    s_branch L_spin_3
L_spind_4:
    s_mov_b32 m0, 36864
    s_add_u32 s64, s64, s63
    s_and_b32 s64, s64, s66
    buffer_load_dwordx4 v16, s[44:47], s64 offen nt lds
    s_waitcnt vmcnt(32)
    s_add_u32 m0, m0, s63
    s_add_u32 s64, s64, s63
    s_and_b32 s64, s64, s66
    buffer_load_dwordx4 v17, s[44:47], s64 offen nt lds
    s_waitcnt vmcnt(32)
    s_add_u32 m0, m0, s63
    s_add_u32 s64, s64, s63
    s_and_b32 s64, s64, s66
    buffer_load_dwordx4 v18, s[44:47], s64 offen nt lds
    s_waitcnt vmcnt(32)
    s_add_u32 m0, m0, s63
    s_add_u32 s64, s64, s63
    s_and_b32 s64, s64, s66
    buffer_load_dwordx4 v19, s[44:47], s64 offen nt lds
    s_waitcnt vmcnt(32)
    s_mov_b32 m0, 40960
    s_add_u32 s64, s64, s63
    s_and_b32 s64, s64, s66
    buffer_load_dwordx4 v16, s[44:47], s64 offen nt lds
    s_waitcnt vmcnt(32)
    s_add_u32 m0, m0, s63
    s_add_u32 s64, s64, s63
    s_and_b32 s64, s64, s66
    buffer_load_dwordx4 v17, s[44:47], s64 offen nt lds
    s_waitcnt vmcnt(32)
    s_add_u32 m0, m0, s63
    s_add_u32 s64, s64, s63
    s_and_b32 s64, s64, s66
    buffer_load_dwordx4 v18, s[44:47], s64 offen nt lds
    s_waitcnt vmcnt(32)
    s_add_u32 m0, m0, s63
    s_add_u32 s64, s64, s63
    s_and_b32 s64, s64, s66
    buffer_load_dwordx4 v19, s[44:47], s64 offen nt lds
    s_waitcnt vmcnt(32)
    s_mov_b32 m0, 45056
    s_add_u32 s64, s64, s63
    s_and_b32 s64, s64, s66
    buffer_load_dwordx4 v16, s[44:47], s64 offen nt lds
    s_waitcnt vmcnt(32)
    s_add_u32 m0, m0, s63
    s_add_u32 s64, s64, s63
    s_and_b32 s64, s64, s66
    buffer_load_dwordx4 v17, s[44:47], s64 offen nt lds
    s_waitcnt vmcnt(32)
    s_add_u32 m0, m0, s63
    s_add_u32 s64, s64, s63
    s_and_b32 s64, s64, s66
    buffer_load_dwordx4 v18, s[44:47], s64 offen nt lds
    s_waitcnt vmcnt(32)
    s_add_u32 m0, m0, s63
    s_add_u32 s64, s64, s63
    s_and_b32 s64, s64, s66
    buffer_load_dwordx4 v19, s[44:47], s64 offen nt lds
    s_waitcnt vmcnt(32)
    v_mov_b32 v5, 3
    ds_write_b32 v3, v5
    s_mov_b32 m0, 49152
    s_add_u32 s64, s64, s63
    s_and_b32 s64, s64, s66
    buffer_load_dwordx4 v16, s[44:47], s64 offen nt lds
    s_waitcnt vmcnt(32)
    s_add_u32 m0, m0, s63
    s_add_u32 s64, s64, s63
    s_and_b32 s64, s64, s66
    buffer_load_dwordx4 v17, s[44:47], s64 offen nt lds
    s_waitcnt vmcnt(32)
    s_add_u32 m0, m0, s63
    s_add_u32 s64, s64, s63
    s_and_b32 s64, s64, s66
    buffer_load_dwordx4 v18, s[44:47], s64 offen nt lds
    s_waitcnt vmcnt(32)
    s_add_u32 m0, m0, s63
    s_add_u32 s64, s64, s63
    s_and_b32 s64, s64, s66
    buffer_load_dwordx4 v19, s[44:47], s64 offen nt lds
    s_waitcnt vmcnt(32)
    s_mov_b32 m0, 53248
    s_add_u32 s64, s64, s63
    s_and_b32 s64, s64, s66
    buffer_load_dwordx4 v16, s[44:47], s64 offen nt lds
    s_waitcnt vmcnt(32)
    s_add_u32 m0, m0, s63
    s_add_u32 s64, s64, s63
    s_and_b32 s64, s64, s66
    buffer_load_dwordx4 v17, s[44:47], s64 offen nt lds
    s_waitcnt vmcnt(32)
    s_add_u32 m0, m0, s63
    s_add_u32 s64, s64, s63
    s_and_b32 s64, s64, s66
    buffer_load_dwordx4 v18, s[44:47], s64 offen nt lds
    s_waitcnt vmcnt(32)
    s_add_u32 m0, m0, s63
    s_add_u32 s64, s64, s63
    s_and_b32 s64, s64, s66
    buffer_load_dwordx4 v19, s[44:47], s64 offen nt lds
    s_waitcnt vmcnt(32)
    s_mov_b32 m0, 57344
    s_add_u32 s64, s64, s63
    s_and_b32 s64, s64, s66
    buffer_load_dwordx4 v16, s[44:47], s64 offen nt lds
    s_waitcnt vmcnt(32)
    s_add_u32 m0, m0, s63
    s_add_u32 s64, s64, s63
    s_and_b32 s64, s64, s66
    buffer_load_dwordx4 v17, s[44:47], s64 offen nt lds
    s_waitcnt vmcnt(32)
    s_add_u32 m0, m0, s63
    s_add_u32 s64, s64, s63
    s_and_b32 s64, s64, s66
    buffer_load_dwordx4 v18, s[44:47], s64 offen nt lds
    s_waitcnt vmcnt(32)
    s_add_u32 m0, m0, s63
    s_add_u32 s64, s64, s63
    s_and_b32 s64, s64, s66
    buffer_load_dwordx4 v19, s[44:47], s64 offen nt lds
    s_waitcnt vmcnt(32)
    s_mov_b32 m0, 61440
    s_add_u32 s64, s64, s63
    s_and_b32 s64, s64, s66
    buffer_load_dwordx4 v16, s[44:47], s64 offen nt lds
    s_waitcnt vmcnt(32)
    s_add_u32 m0, m0, s63
    s_add_u32 s64, s64, s63
    s_and_b32 s64, s64, s66
    buffer_load_dwordx4 v17, s[44:47], s64 offen nt lds
    s_waitcnt vmcnt(32)
    s_add_u32 m0, m0, s63
    s_add_u32 s64, s64, s63
    s_and_b32 s64, s64, s66
    buffer_load_dwordx4 v18, s[44:47], s64 offen nt lds
    s_waitcnt vmcnt(32)
    s_add_u32 m0, m0, s63
    s_add_u32 s64, s64, s63
    s_and_b32 s64, s64, s66
    buffer_load_dwordx4 v19, s[44:47], s64 offen nt lds
    s_waitcnt vmcnt(32)
    v_mov_b32 v5, 4
    ds_write_b32 v3, v5
L_spin_5:
    ds_read_b32 v1, v4 offset:284
    s_waitcnt lgkmcnt(0)
    v_readfirstlane_b32 s56, v1
    s_nop 0
    s_cmp_ge_u32 s56, 4
    s_cbranch_scc1 L_spind_6
    s_sleep 1
    s_branch L_spin_5
L_spind_6:
    s_mov_b32 m0, 65536
    s_add_u32 s67, s68, 0
    buffer_load_dwordx4 v20, s[48:51], s67 offen offset:0 nt lds
    s_waitcnt vmcnt(44)
    buffer_load_dwordx4 v21, s[48:51], s67 offen offset:1024 nt lds
    s_waitcnt vmcnt(44)
    buffer_load_dwordx4 v22, s[48:51], s67 offen offset:2048 nt lds
    s_waitcnt vmcnt(44)
    buffer_load_dwordx4 v23, s[48:51], s67 offen offset:3072 nt lds
    s_waitcnt vmcnt(44)
    s_mov_b32 m0, 69632
    s_add_u32 s67, s68, 4096
    buffer_load_dwordx4 v24, s[48:51], s67 offen offset:0 nt lds
    s_waitcnt vmcnt(44)
    buffer_load_dwordx4 v25, s[48:51], s67 offen offset:1024 nt lds
    s_waitcnt vmcnt(44)
    buffer_load_dwordx4 v26, s[48:51], s67 offen offset:2048 nt lds
    s_waitcnt vmcnt(44)
    s_mov_b32 m0, 72704
    s_add_u32 s67, s68, 7168
    buffer_load_dwordx4 v20, s[48:51], s67 offen offset:0 nt lds
    s_waitcnt vmcnt(44)
    buffer_load_dwordx4 v21, s[48:51], s67 offen offset:1024 nt lds
    s_waitcnt vmcnt(44)
    buffer_load_dwordx4 v22, s[48:51], s67 offen offset:2048 nt lds
    s_waitcnt vmcnt(44)
    buffer_load_dwordx4 v23, s[48:51], s67 offen offset:3072 nt lds
    s_waitcnt vmcnt(44)
    s_mov_b32 m0, 76800
    s_add_u32 s67, s68, 11264
    buffer_load_dwordx4 v24, s[48:51], s67 offen offset:0 nt lds
    s_waitcnt vmcnt(44)
    buffer_load_dwordx4 v25, s[48:51], s67 offen offset:1024 nt lds
    s_waitcnt vmcnt(44)
    buffer_load_dwordx4 v26, s[48:51], s67 offen offset:2048 nt lds
    s_waitcnt vmcnt(44)
    s_mov_b32 m0, 79872
    s_add_u32 s67, s68, 14336
    buffer_load_dwordx4 v28, s[48:51], s67 offen offset:0 nt lds
    s_waitcnt vmcnt(44)
    buffer_load_dwordx4 v29, s[48:51], s67 offen offset:1024 nt lds
    s_waitcnt vmcnt(44)
    buffer_load_dwordx4 v30, s[48:51], s67 offen offset:2048 nt lds
    s_waitcnt vmcnt(44)
    buffer_load_dwordx4 v31, s[48:51], s67 offen offset:3072 nt lds
    s_waitcnt vmcnt(44)
    s_mov_b32 m0, 83968
    s_add_u32 s67, s68, 18432
    buffer_load_dwordx4 v32, s[48:51], s67 offen offset:0 nt lds
    s_waitcnt vmcnt(44)
    buffer_load_dwordx4 v33, s[48:51], s67 offen offset:1024 nt lds
    s_waitcnt vmcnt(44)
    buffer_load_dwordx4 v34, s[48:51], s67 offen offset:2048 nt lds
    s_waitcnt vmcnt(44)
    s_mov_b32 m0, 87040
    s_add_u32 s67, s68, 21504
    buffer_load_dwordx4 v28, s[48:51], s67 offen offset:0 nt lds
    s_waitcnt vmcnt(44)
    buffer_load_dwordx4 v29, s[48:51], s67 offen offset:1024 nt lds
    s_waitcnt vmcnt(44)
    buffer_load_dwordx4 v30, s[48:51], s67 offen offset:2048 nt lds
    s_waitcnt vmcnt(44)
    buffer_load_dwordx4 v31, s[48:51], s67 offen offset:3072 nt lds
    s_waitcnt vmcnt(44)
    s_mov_b32 m0, 91136
    s_add_u32 s67, s68, 25600
    buffer_load_dwordx4 v32, s[48:51], s67 offen offset:0 nt lds
    s_waitcnt vmcnt(44)
    buffer_load_dwordx4 v33, s[48:51], s67 offen offset:1024 nt lds
    s_waitcnt vmcnt(44)
    buffer_load_dwordx4 v34, s[48:51], s67 offen offset:2048 nt lds
    s_waitcnt vmcnt(44)
    v_mov_b32 v5, 5
    ds_write_b32 v3, v5
    s_waitcnt vmcnt(28)
    s_barrier
    s_waitcnt vmcnt(0)
    v_mov_b32 v5, 7
    ds_write_b32 v3, v5
    s_cmp_eq_u32 s2, 255
    s_cbranch_scc1 L_epoch
    s_endpgm
L_compute:
    v_mov_b32 v2, 159744
    v_mov_b32 v3, 1
    v_and_b32 v4, 3, v0
    v_bfe_u32 v6, v0, 2, 2
    v_and_b32 v7, 15, v0
    s_load_dword s32, s[26:27], 0
    s_mov_b32 s36, s26
    s_mov_b32 s37, s27
    s_mov_b32 s38, 4194304
    s_mov_b32 s39, 0x20000
    s_barrier
    s_cmp_lt_u32 s34, 32
    s_cbranch_scc0 L_norole
    v_add_u32 v120, s62, v121
    v_cmp_gt_u32 s[52:53], 56, v0
    v_lshrrev_b32 v12, 2, v0
    v_lshlrev_b32 v12, 7, v12
    v_lshl_add_u32 v12, v4, 3, v12
    v_bfe_u32 v1, v0, 3, 2
    v_xor_b32 v1, s3, v1
    v_lshl_add_u32 v124, v1, 5, v12
    v_add_u32 v124, 131072, v124
    v_add_u32 v120, 0, v120
    s_movk_i32 s56, 896
    v_mul_u32_u24 v123, s56, v4
    v_lshl_add_u32 v123, v5, 4, v123
    s_mul_i32 s56, s57, 448
    s_add_u32 s56, s56, 0
    v_add_u32 v123, s56, v123
    s_lshl_b32 s56, s3, 6
    s_add_u32 s56, s56, 161280
    v_lshl_add_u32 v125, v5, 4, s56
    v_lshl_add_u32 v125, v4, 8, v125
    s_waitcnt vmcnt(7)
    s_mov_b32 s56, 0xffff0000
    v_lshlrev_b32 v24, 16, v8
    v_and_b32 v25, s56, v8
    v_lshlrev_b32 v26, 16, v9
    v_and_b32 v27, s56, v9
    v_lshlrev_b32 v28, 16, v10
    v_and_b32 v29, s56, v10
    v_lshlrev_b32 v30, 16, v11
    v_and_b32 v31, s56, v11
    v_pk_add_f32 v[32:33], v[24:25], v[26:27]
    v_pk_add_f32 v[34:35], v[28:29], v[30:31]
    v_pk_add_f32 v[32:33], v[32:33], v[34:35]
    v_add_f32 v32, v32, v33
    s_nop 1
    v_add_f32_dpp v32, v32, v32 row_ror:1 row_mask:0xf bank_mask:0xf
    s_nop 1
    v_add_f32_dpp v32, v32, v32 row_ror:2 row_mask:0xf bank_mask:0xf
    s_nop 1
    v_add_f32_dpp v32, v32, v32 row_ror:4 row_mask:0xf bank_mask:0xf
    s_nop 1
    v_add_f32_dpp v32, v32, v32 row_ror:8 row_mask:0xf bank_mask:0xf
    v_mov_b32 v33, v32
    s_nop 1
    v_permlane16_swap_b32 v32, v33
    v_add_f32 v32, v32, v33
    v_mov_b32 v33, v32
    s_nop 1
    v_permlane32_swap_b32 v32, v33
    v_add_f32 v32, v32, v33
    v_mul_f32 v32, 0xbb124925, v32
    v_cndmask_b32 v34, 0, v32, s[52:53]
    v_mov_b32 v35, v34
    v_pk_add_f32 v[40:41], v[24:25], v[34:35]
    v_pk_add_f32 v[42:43], v[26:27], v[34:35]
    v_pk_add_f32 v[44:45], v[28:29], v[34:35]
    v_pk_add_f32 v[46:47], v[30:31], v[34:35]
    v_pk_mul_f32 v[36:37], v[40:41], v[40:41]
    v_pk_mul_f32 v[38:39], v[42:43], v[42:43]
    v_pk_fma_f32 v[36:37], v[44:45], v[44:45], v[36:37]
    v_pk_fma_f32 v[38:39], v[46:47], v[46:47], v[38:39]
    v_pk_add_f32 v[36:37], v[36:37], v[38:39]
    v_add_f32 v36, v36, v37
    s_nop 1
    v_add_f32_dpp v36, v36, v36 row_ror:1 row_mask:0xf bank_mask:0xf
    s_nop 1
    v_add_f32_dpp v36, v36, v36 row_ror:2 row_mask:0xf bank_mask:0xf
    s_nop 1
    v_add_f32_dpp v36, v36, v36 row_ror:4 row_mask:0xf bank_mask:0xf
    s_nop 1
    v_add_f32_dpp v36, v36, v36 row_ror:8 row_mask:0xf bank_mask:0xf
    v_mov_b32 v37, v36
    s_nop 1
    v_permlane16_swap_b32 v36, v37
    v_add_f32 v36, v36, v37
    v_mov_b32 v37, v36
    s_nop 1
    v_permlane32_swap_b32 v36, v37
    v_add_f32 v36, v36, v37
    v_mul_f32 v36, 0x3b124925, v36
    v_cvt_pk_bf16_f32 v36, v36, v32
    v_and_b32 v32, s56, v36
    v_lshlrev_b32 v36, 16, v36
    v_add_f32 v36, 0x3727c5ac, v36
    v_mov_b32 v33, v32
    v_cvt_pk_bf16_f32 v36, v36, v36
    v_and_b32 v36, s56, v36
    v_sqrt_f32 v36, v36
    v_pk_add_f32 v[24:25], v[24:25], v[32:33]
    v_pk_add_f32 v[26:27], v[26:27], v[32:33]
    v_pk_add_f32 v[28:29], v[28:29], v[32:33]
    v_pk_add_f32 v[30:31], v[30:31], v[32:33]
    v_cvt_pk_bf16_f32 v36, v36, v36
    v_and_b32 v36, s56, v36
    v_rcp_f32 v36, v36
    v_cvt_pk_bf16_f32 v8, v24, v25
    v_cvt_pk_bf16_f32 v9, v26, v27
    v_cvt_pk_bf16_f32 v10, v28, v29
    v_cvt_pk_bf16_f32 v11, v30, v31
    v_mov_b32 v37, v36
    v_lshlrev_b32 v24, 16, v8
    v_and_b32 v25, s56, v8
    v_lshlrev_b32 v26, 16, v9
    v_and_b32 v27, s56, v9
    v_lshlrev_b32 v28, 16, v10
    v_and_b32 v29, s56, v10
    v_lshlrev_b32 v30, 16, v11
    v_and_b32 v31, s56, v11
    v_pk_mul_f32 v[24:25], v[24:25], v[36:37]
    v_pk_mul_f32 v[26:27], v[26:27], v[36:37]
    v_pk_mul_f32 v[28:29], v[28:29], v[36:37]
    v_pk_mul_f32 v[30:31], v[30:31], v[36:37]
    v_cvt_pk_bf16_f32 v8, v24, v25
    v_cvt_pk_bf16_f32 v9, v26, v27
    v_cvt_pk_bf16_f32 v10, v28, v29
    v_cvt_pk_bf16_f32 v11, v30, v31
    s_mov_b64 exec, s[52:53]
    ds_write_b128 v120, v[8:11]
    s_waitcnt vmcnt(0) lgkmcnt(0)
    s_mov_b64 exec, 1
    ds_add_u32 v2, v3 offset:272
    s_mov_b64 exec, -1
L_spin_7:
    ds_read_b32 v1, v2 offset:272
    s_waitcnt lgkmcnt(0)
    v_readfirstlane_b32 s56, v1
    s_nop 0
    s_cmp_ge_u32 s56, 4
    s_cbranch_scc0 L_spin_7
    ds_read_b128 v[8:11], v123 offset:0
    ds_read_b64_tr_b16 v[40:41], v124 offset:0
    ds_read_b64_tr_b16 v[42:43], v124 offset:2048
    ds_read_b128 v[12:15], v123 offset:64
    ds_read_b64_tr_b16 v[44:45], v124 offset:4096
    ds_read_b64_tr_b16 v[46:47], v124 offset:6144
    ds_read_b128 v[16:19], v123 offset:128
    ds_read_b64_tr_b16 v[48:49], v124 offset:8192
    ds_read_b64_tr_b16 v[50:51], v124 offset:10240
    ds_read_b128 v[20:23], v123 offset:192
    ds_read_b64_tr_b16 v[52:53], v124 offset:12288
    ds_read_b64_tr_b16 v[54:55], v124 offset:14336
    s_waitcnt lgkmcnt(9)
    v_mfma_f32_16x16x32_bf16 v[88:91], v[40:43], v[8:11], 0
    ds_read_b128 v[24:27], v123 offset:256
    ds_read_b64_tr_b16 v[56:57], v124 offset:16384
    ds_read_b64_tr_b16 v[58:59], v124 offset:18432
    s_waitcnt lgkmcnt(9)
    v_mfma_f32_16x16x32_bf16 v[88:91], v[44:47], v[12:15], v[88:91]
    ds_read_b128 v[28:31], v123 offset:320
    ds_read_b64_tr_b16 v[60:61], v124 offset:20480
    ds_read_b64_tr_b16 v[62:63], v124 offset:22528
    s_waitcnt lgkmcnt(9)
    v_mfma_f32_16x16x32_bf16 v[88:91], v[48:51], v[16:19], v[88:91]
    ds_read_b128 v[32:35], v123 offset:384
    ds_read_b64_tr_b16 v[64:65], v124 offset:24576
    ds_read_b64_tr_b16 v[66:67], v124 offset:26624
    s_waitcnt lgkmcnt(9)
    v_mfma_f32_16x16x32_bf16 v[88:91], v[52:55], v[20:23], v[88:91]
    s_waitcnt lgkmcnt(6)
    v_mfma_f32_16x16x32_bf16 v[88:91], v[56:59], v[24:27], v[88:91]
    s_waitcnt lgkmcnt(3)
    v_mfma_f32_16x16x32_bf16 v[88:91], v[60:63], v[28:31], v[88:91]
    s_waitcnt lgkmcnt(0)
    v_mfma_f32_16x16x32_bf16 v[88:91], v[64:67], v[32:35], v[88:91]
    s_mov_b32 exec_lo, 0x000f000f
    s_mov_b32 exec_hi, 0x000f000f
    s_nop 5
    ds_write_b128 v125, v[88:91]
    s_waitcnt lgkmcnt(0)
L_norole:
    s_waitcnt vmcnt(0) lgkmcnt(0)
    s_mov_b64 exec, 1
    ds_add_u32 v2, v3 offset:256
    s_mov_b64 exec, -1
    s_waitcnt lgkmcnt(0)
    s_mul_i32 s32, s32, 1664525
    s_add_u32 s32, s32, 1013904223
L_adone:
    v_bfe_u32 v8, v0, 2, 1
    v_bfe_u32 v9, v0, 3, 1
    v_lshl_add_u32 v1, v8, 1, v9
    v_lshlrev_b32 v8, 2, v8
    v_add_u32 v8, v8, v9
    v_lshrrev_b32 v9, 5, v0
    v_lshl_add_u32 v8, v9, 1, v8
    v_bfe_u32 v9, v0, 4, 1
    v_lshl_add_u32 v8, v8, 2, v9
    v_and_b32 v9, 3, v0
    v_lshlrev_b32 v9, 3, v9
    s_movk_i32 s56, 896
    v_mad_u32_u24 v8, v8, s56, v9
    v_lshrrev_b32 v10, 2, v0
    v_add_u32 v8, 65536, v8
    s_mul_i32 s56, s3, 7
    v_xor_b32 v9, s56, v1
    v_lshl_add_u32 v200, v9, 5, v8
    v_add_u32 v184, -28672, v200
    s_add_u32 s56, s56, 1
    v_xor_b32 v9, s56, v1
    v_lshl_add_u32 v201, v9, 5, v8
    v_add_u32 v185, -28672, v201
    s_add_u32 s56, s56, 1
    v_xor_b32 v9, s56, v1
    v_lshl_add_u32 v202, v9, 5, v8
    v_add_u32 v186, -28672, v202
    s_add_u32 s56, s56, 1
    v_xor_b32 v9, s56, v1
    v_lshl_add_u32 v203, v9, 5, v8
    v_add_u32 v187, -28672, v203
    s_add_u32 s56, s56, 1
    v_xor_b32 v9, s56, v1
    v_lshl_add_u32 v204, v9, 5, v8
    v_add_u32 v188, -28672, v204
    s_add_u32 s56, s56, 1
    v_xor_b32 v9, s56, v1
    v_lshl_add_u32 v205, v9, 5, v8
    v_add_u32 v189, -28672, v205
    s_add_u32 s56, s56, 1
    v_xor_b32 v9, s56, v1
    v_lshl_add_u32 v206, v9, 5, v8
    v_add_u32 v190, -28672, v206
    s_mov_b32 s62, 0x07060500
    s_mov_b32 s63, 0x07060501
    s_mov_b32 s68, 0x07060502
    s_mov_b32 s69, 0x07060503
    s_mov_b32 s66, 0x0c0c0400
    s_mov_b32 s67, 0x04000c0c
    s_lshl_b32 s56, s3, 14
    s_add_u32 s56, s56, 65536
    v_lshl_add_u32 v8, v7, 9, s56
    v_xor_b32 v9, v5, v7
    v_xor_b32 v1, 0, v9
    v_lshl_add_u32 v208, v1, 4, v8
    v_xor_b32 v1, 4, v9
    v_lshl_add_u32 v209, v1, 4, v8
    v_xor_b32 v1, 8, v9
    v_lshl_add_u32 v210, v1, 4, v8
    v_xor_b32 v1, 12, v9
    v_lshl_add_u32 v211, v1, 4, v8
    v_and_b32 v11, 1, v0
    v_lshlrev_b32 v1, 9, v11
    v_lshl_add_u32 v212, v5, 4, v1
    v_add_u32 v212, 160256, v212
    s_lshl_b32 s56, s3, 9
    s_add_u32 s56, s56, 122880
    v_lshl_add_u32 v1, v11, 8, s56
    v_lshl_add_u32 v213, v5, 4, v1
    v_lshl_add_u32 v1, v5, 6, s56
    v_bfe_u32 v8, v0, 1, 2
    v_lshl_add_u32 v1, v8, 4, v1
    v_bfe_u32 v12, v0, 3, 1
    v_lshl_add_u32 v1, v12, 3, v1
    v_lshl_add_u32 v218, v11, 2, v1
    s_lshl_b32 s56, s3, 7
    s_add_u32 s56, s56, 163328
    v_lshl_add_u32 v214, v0, 2, s56
    v_lshlrev_b32 v215, 3, v0
    v_add_u32 v215, 163328, v215
    v_lshlrev_b32 v8, 9, v10
    v_lshl_add_u32 v8, v4, 3, v8
    v_and_b32 v9, 7, v10
    s_lshl_b32 s56, s3, 2
    v_xor_b32 v1, s56, v9
    v_lshl_add_u32 v192, v1, 5, v8
    s_add_u32 s56, s56, 1
    v_xor_b32 v1, s56, v9
    v_lshl_add_u32 v193, v1, 5, v8
    s_add_u32 s56, s56, 1
    v_xor_b32 v1, s56, v9
    v_lshl_add_u32 v194, v1, 5, v8
    s_add_u32 s56, s56, 1
    v_xor_b32 v1, s56, v9
    v_lshl_add_u32 v195, v1, 5, v8
    v_bfe_u32 v1, v0, 2, 1
    v_lshlrev_b32 v1, 8, v1
    v_lshl_add_u32 v1, v5, 6, v1
    v_lshl_add_u32 v219, v4, 4, v1
    v_bfe_u32 v8, v0, 1, 2
    s_lshl_b32 s56, s30, 3
    s_add_u32 s56, s56, s28
    s_mul_i32 s56, s56, 17408
    s_add_u32 s34, s56, 393216
    s_mul_i32 s56, s31, 2176
    s_add_u32 s35, s34, s56
    s_lshl_b32 s56, s3, 9
    s_add_u32 s48, s35, s56
    s_add_u32 s49, s48, 1703936
    s_add_u32 s50, s35, 1703936
    v_cmp_eq_u32 s[8:9], 1, v8
    v_cmp_eq_u32 s[10:11], 2, v8
    v_cmp_eq_u32 s[12:13], 3, v8
    v_lshrrev_b32 v1, 3, v0
    s_movk_i32 s56, 2176
    v_mul_u32_u24 v1, s56, v1
    v_and_b32 v9, 7, v0
    v_lshl_add_u32 v1, v9, 4, v1
    v_add_u32 v221, 2048, v1
    s_lshl_b32 s56, s31, 8
    v_add_u32 v220, s56, v1
    v_and_b32 v8, 1, v5
    v_cmp_eq_u32 s[14:15], 1, v11
    s_mov_b32 s16, 0x20002
    s_mov_b32 s17, s16
    s_mov_b32 s18, 0x40004
    s_mov_b32 s19, s18
    s_mov_b32 s20, 0x80008
    s_mov_b32 s21, s20
    s_mov_b32 s22, 0x100010
    s_mov_b32 s23, s22
    s_mov_b32 s24, 0x200020
    s_mov_b32 s25, s24
    s_mov_b32 s26, 0x400040
    s_mov_b32 s27, s26
    v_cmp_eq_u32 s[52:53], 1, v8
    v_cmp_eq_u32 s[54:55], 1, v12
    s_and_b32 s56, s30, 1
    s_lshl_b32 s56, s56, 4
    s_lshl1_add_u32 s56, s28, s56
    s_lshr_b32 s57, s31, 2
    s_add_u32 s56, s56, s57
    s_lshl_b32 s56, s56, 1
    s_lshr_b32 s57, s30, 1
    s_xor_b32 s57, s57, 0
    s_add_u32 s56, s56, s57
    s_lshl_b32 s56, s56, 2
    s_and_b32 s57, s31, 3
    s_add_u32 s56, s56, s57
    s_lshl_b32 s56, s56, 11
    s_lshl_b32 s57, s3, 9
    s_add_u32 s56, s56, s57
    s_add_u32 s33, s56, 1048576
    v_lshlrev_b32 v1, 4, v7
    v_lshl_add_u32 v207, v5, 7, v1
    v_mov_b32 v199, s32
    s_getreg_b32 s56, hwreg(HW_REG_XCC_ID)
    s_and_b32 s56, s56, 15
    s_add_u32 s56, s56, 1
    s_mul_i32 s56, s56, 0x9e3779b1
    s_xor_b32 s47, s32, s56
    v_mov_b32 v198, s47
    v_mov_b32 v197, 0x80
    v_lshlrev_b32 v124, 4, v0
    s_mov_b32 s64, 0xffff0000
    s_mov_b32 s65, 0x3db8aa3b
    s_mov_b32 s51, 0xffffff00
L_spin_9:
    ds_read_b32 v1, v2 offset:0
    s_waitcnt lgkmcnt(0)
    v_readfirstlane_b32 s56, v1
    s_nop 0
    s_cmp_ge_u32 s56, 1
    s_cbranch_scc1 L_spind_10
    s_sleep 1
    s_branch L_spin_9
L_spind_10:
    ds_read_b64_tr_b16 v[128:129], v184 offset:0
    ds_read_b64_tr_b16 v[130:131], v184 offset:1792
    ds_read_b64_tr_b16 v[132:133], v185 offset:0
    ds_read_b64_tr_b16 v[134:135], v185 offset:1792
    ds_read_b64_tr_b16 v[136:137], v186 offset:0
    ds_read_b64_tr_b16 v[138:139], v186 offset:1792
    ds_read_b64_tr_b16 v[140:141], v187 offset:0
    ds_read_b64_tr_b16 v[142:143], v187 offset:1792
    ds_read_b64_tr_b16 v[144:145], v188 offset:0
    ds_read_b64_tr_b16 v[146:147], v188 offset:1792
    ds_read_b64_tr_b16 v[148:149], v189 offset:0
    ds_read_b64_tr_b16 v[150:151], v189 offset:1792
    ds_read_b64_tr_b16 v[152:153], v190 offset:0
    ds_read_b64_tr_b16 v[154:155], v190 offset:1792
    s_waitcnt lgkmcnt(0)
    s_mov_b64 exec, 1
    ds_add_u32 v2, v3 offset:276
    s_mov_b64 exec, -1
L_spin_11:
    ds_read_b32 v1, v2 offset:0
    s_waitcnt lgkmcnt(0)
    v_readfirstlane_b32 s56, v1
    s_nop 0
    s_cmp_ge_u32 s56, 2
    s_cbranch_scc1 L_spind_12
    s_sleep 1
    s_branch L_spin_11
L_spind_12:
    ds_read_b128 v[40:43], v208 offset:0
    ds_read_b128 v[44:47], v208 offset:8192
    ds_read_b128 v[48:51], v209 offset:0
    ds_read_b128 v[52:55], v209 offset:8192
    ds_read_b128 v[56:59], v210 offset:0
    ds_read_b128 v[60:63], v210 offset:8192
    ds_read_b128 v[64:67], v211 offset:0
    ds_read_b128 v[68:71], v211 offset:8192
    ds_read_b128 v[72:75], v208 offset:256
    ds_read_b128 v[76:79], v208 offset:8448
    ds_read_b128 v[80:83], v209 offset:256
    ds_read_b128 v[84:87], v209 offset:8448
    ds_read_b128 v[88:91], v210 offset:256
    ds_read_b128 v[92:95], v210 offset:8448
    ds_read_b128 v[96:99], v211 offset:256
    ds_read_b128 v[100:103], v211 offset:8448
    s_waitcnt lgkmcnt(0)
    s_mov_b64 exec, 1
    ds_add_u32 v2, v3 offset:284
    s_mov_b64 exec, -1
L_spin_13:
    ds_read_b32 v1, v2 offset:260
    s_waitcnt lgkmcnt(0)
    v_readfirstlane_b32 s56, v1
    s_nop 0
    s_cmp_ge_u32 s56, 1
    s_cbranch_scc0 L_spin_13
    ds_read_b32 v1, v2 offset:288
    ds_read_b128 v[8:11], v212 offset:0
    ds_read_b128 v[12:15], v212 offset:64
    ds_read_b128 v[16:19], v212 offset:128
    ds_read_b128 v[20:23], v212 offset:192
    ds_read_b128 v[24:27], v212 offset:256
    ds_read_b128 v[28:31], v212 offset:320
    ds_read_b128 v[32:35], v212 offset:384
    ds_read_b128 v[36:39], v212 offset:448
    s_waitcnt lgkmcnt(7)
    v_mfma_f32_16x16x32_bf16 v[104:107], v[8:11], v[40:43], 0
    v_mfma_f32_16x16x32_bf16 v[108:111], v[8:11], v[44:47], 0
    s_waitcnt lgkmcnt(6)
    v_mfma_f32_16x16x32_bf16 v[104:107], v[12:15], v[48:51], v[104:107]
    v_mfma_f32_16x16x32_bf16 v[108:111], v[12:15], v[52:55], v[108:111]
    s_waitcnt lgkmcnt(5)
    v_mfma_f32_16x16x32_bf16 v[104:107], v[16:19], v[56:59], v[104:107]
    v_mfma_f32_16x16x32_bf16 v[108:111], v[16:19], v[60:63], v[108:111]
    s_waitcnt lgkmcnt(4)
    v_mfma_f32_16x16x32_bf16 v[104:107], v[20:23], v[64:67], v[104:107]
    v_mfma_f32_16x16x32_bf16 v[108:111], v[20:23], v[68:71], v[108:111]
    s_waitcnt lgkmcnt(3)
    v_mfma_f32_16x16x32_bf16 v[104:107], v[24:27], v[72:75], v[104:107]
    v_mfma_f32_16x16x32_bf16 v[108:111], v[24:27], v[76:79], v[108:111]
    s_waitcnt lgkmcnt(2)
    v_mfma_f32_16x16x32_bf16 v[104:107], v[28:31], v[80:83], v[104:107]
    v_mfma_f32_16x16x32_bf16 v[108:111], v[28:31], v[84:87], v[108:111]
    s_waitcnt lgkmcnt(1)
    v_mfma_f32_16x16x32_bf16 v[104:107], v[32:35], v[88:91], v[104:107]
    v_mfma_f32_16x16x32_bf16 v[108:111], v[32:35], v[92:95], v[108:111]
    s_waitcnt lgkmcnt(0)
    v_mfma_f32_16x16x32_bf16 v[104:107], v[36:39], v[96:99], v[104:107]
    v_mfma_f32_16x16x32_bf16 v[108:111], v[36:39], v[100:103], v[108:111]
    v_readfirstlane_b32 s56, v1
    s_nop 0
    s_xor_b32 s33, s33, s56
    s_nop 4
    v_cndmask_b32 v8, v104, v108, s[52:53]
    v_cndmask_b32 v9, v105, v109, s[52:53]
    v_cvt_pk_bf16_f32 v8, v8, v9
    s_mov_b32 exec_hi, 0
    ds_write_b32 v214, v8
    s_waitcnt lgkmcnt(0)
    s_mov_b64 exec, 1
    ds_add_u32 v2, v3 offset:264
    s_mov_b64 exec, -1
L_spin_15:
    ds_read_b32 v1, v2 offset:264
    s_waitcnt lgkmcnt(0)
    v_readfirstlane_b32 s56, v1
    s_nop 0
    s_cmp_ge_u32 s56, 4
    s_cbranch_scc0 L_spin_15
    ds_read_b64 v[8:9], v215
    s_waitcnt lgkmcnt(0)
    v_lshlrev_b32 v16, 16, v8
    v_lshlrev_b32 v17, 16, v9
    v_and_b32 v18, s64, v8
    v_and_b32 v19, s64, v9
    v_max_f32 v24, v16, v17
    v_max_f32 v25, v18, v19
    s_nop 1
    v_permlane32_swap_b32 v24, v25
    v_max_f32 v24, v24, v25
    v_mov_b32 v25, v24
    s_nop 1
    v_permlane16_swap_b32 v24, v25
    v_max_f32 v24, v24, v25
    s_nop 1
    v_max_f32_dpp v24, v24, v24 row_ror:1 row_mask:0xf bank_mask:0xf
    s_nop 1
    v_max_f32_dpp v24, v24, v24 row_ror:2 row_mask:0xf bank_mask:0xf
    s_nop 1
    v_max_f32_dpp v24, v24, v24 row_ror:4 row_mask:0xf bank_mask:0xf
    s_nop 1
    v_max_f32_dpp v24, v24, v24 row_ror:8 row_mask:0xf bank_mask:0xf
    s_nop 0
    v_readlane_b32 s56, v24, 0
    v_readlane_b32 s57, v24, 32
    s_nop 0
    v_subrev_f32 v16, s56, v16
    v_subrev_f32 v17, s56, v17
    v_subrev_f32 v18, s57, v18
    v_subrev_f32 v19, s57, v19
    v_mul_f32 v16, s65, v16
    v_mul_f32 v17, s65, v17
    v_mul_f32 v18, s65, v18
    v_mul_f32 v19, s65, v19
    v_exp_f32 v16, v16
    v_exp_f32 v17, v17
    v_exp_f32 v18, v18
    v_exp_f32 v19, v19
    v_cvt_pk_bf16_f32 v8, v16, v17
    v_cvt_pk_bf16_f32 v9, v18, v19
    ds_write2st64_b32 v218, v8, v9 offset0:0 offset1:1
    v_add_f32 v26, v16, v17
    v_add_f32 v27, v18, v19
    s_nop 1
    v_permlane32_swap_b32 v26, v27
    v_add_f32 v26, v26, v27
    s_waitcnt lgkmcnt(0)
    ds_read_b128 v[8:11], v213 offset:0
    ds_read_b128 v[12:15], v213 offset:64
    ds_read_b128 v[16:19], v213 offset:128
    ds_read_b128 v[20:23], v213 offset:192
    v_mov_b32 v27, v26
    s_nop 1
    v_permlane16_swap_b32 v26, v27
    v_add_f32 v26, v26, v27
    s_nop 1
    v_add_f32_dpp v26, v26, v26 row_ror:1 row_mask:0xf bank_mask:0xf
    s_nop 1
    v_add_f32_dpp v26, v26, v26 row_ror:2 row_mask:0xf bank_mask:0xf
    s_nop 1
    v_add_f32_dpp v26, v26, v26 row_ror:4 row_mask:0xf bank_mask:0xf
    s_nop 1
    v_add_f32_dpp v26, v26, v26 row_ror:8 row_mask:0xf bank_mask:0xf
    s_cmp_lg_u32 s3, 0
    s_cbranch_scc1 L_noml
    v_readlane_b32 s58, v26, 32
    v_mov_b32 v28, s56
    v_mov_b32 v29, v26
    v_mov_b32 v30, s57
    v_mov_b32 v31, s58
    v_perm_b32 v32, v28, v198, s62
    v_perm_b32 v33, v29, v198, s63
    v_perm_b32 v34, v30, v198, s68
    v_perm_b32 v35, v31, v198, s69
    v_perm_b32 v120, v28, v199, s62
    v_perm_b32 v121, v29, v199, s63
    v_perm_b32 v122, v30, v199, s68
    v_perm_b32 v123, v31, v199, s69
    s_mov_b64 exec, 0xff
    buffer_store_dwordx4 v[32:35], v124, s[36:39], s35 offen offset:2048
    s_mov_b64 exec, -1
    v_and_b32 v127, 7, v0
    v_lshl_add_u32 v127, v127, 4, v220
    buffer_load_dword v127, v127, s[36:39], s34 offen sc1
L_noml:
L_spin_17:
    ds_read_b32 v1, v2 offset:0
    s_waitcnt lgkmcnt(0)
    v_readfirstlane_b32 s56, v1
    s_nop 0
    s_cmp_ge_u32 s56, 3
    s_cbranch_scc0 L_spin_17
    ds_read_b64_tr_b16 v[224:225], v192 offset:0
    ds_read_b64_tr_b16 v[226:227], v192 offset:8192
    ds_read_b64_tr_b16 v[228:229], v193 offset:0
    ds_read_b64_tr_b16 v[230:231], v193 offset:8192
    ds_read_b64_tr_b16 v[232:233], v194 offset:0
    ds_read_b64_tr_b16 v[234:235], v194 offset:8192
    ds_read_b64_tr_b16 v[236:237], v195 offset:0
    ds_read_b64_tr_b16 v[238:239], v195 offset:8192
    s_waitcnt lgkmcnt(6)
    v_mfma_f32_16x16x32_bf16 v[104:107], v[224:227], v[8:11], 0
    s_waitcnt lgkmcnt(4)
    v_mfma_f32_16x16x32_bf16 v[108:111], v[228:231], v[8:11], 0
    s_waitcnt lgkmcnt(2)
    v_mfma_f32_16x16x32_bf16 v[112:115], v[232:235], v[8:11], 0
    s_waitcnt lgkmcnt(0)
    v_mfma_f32_16x16x32_bf16 v[116:119], v[236:239], v[8:11], 0
L_spin_19:
    ds_read_b32 v1, v2 offset:0
    s_waitcnt lgkmcnt(0)
    v_readfirstlane_b32 s56, v1
    s_nop 0
    s_cmp_ge_u32 s56, 4
    s_cbranch_scc0 L_spin_19
    ds_read_b64_tr_b16 v[240:241], v192 offset:16384
    ds_read_b64_tr_b16 v[242:243], v192 offset:24576
    ds_read_b64_tr_b16 v[244:245], v193 offset:16384
    ds_read_b64_tr_b16 v[246:247], v193 offset:24576
    ds_read_b64_tr_b16 v[248:249], v194 offset:16384
    ds_read_b64_tr_b16 v[250:251], v194 offset:24576
    ds_read_b64_tr_b16 v[252:253], v195 offset:16384
    ds_read_b64_tr_b16 v[254:255], v195 offset:24576
    s_waitcnt lgkmcnt(6)
    v_mfma_f32_16x16x32_bf16 v[104:107], v[240:243], v[12:15], v[104:107]
    s_waitcnt lgkmcnt(4)
    v_mfma_f32_16x16x32_bf16 v[108:111], v[244:247], v[12:15], v[108:111]
    s_waitcnt lgkmcnt(2)
    v_mfma_f32_16x16x32_bf16 v[112:115], v[248:251], v[12:15], v[112:115]
    s_waitcnt lgkmcnt(0)
    v_mfma_f32_16x16x32_bf16 v[116:119], v[252:255], v[12:15], v[116:119]
L_spin_21:
    ds_read_b32 v1, v2 offset:0
    s_waitcnt lgkmcnt(0)
    v_readfirstlane_b32 s56, v1
    s_nop 0
    s_cmp_ge_u32 s56, 5
    s_cbranch_scc0 L_spin_21
    ds_read_b64_tr_b16 v[224:225], v192 offset:32768
    ds_read_b64_tr_b16 v[226:227], v192 offset:40960
    ds_read_b64_tr_b16 v[228:229], v193 offset:32768
    ds_read_b64_tr_b16 v[230:231], v193 offset:40960
    ds_read_b64_tr_b16 v[232:233], v194 offset:32768
    ds_read_b64_tr_b16 v[234:235], v194 offset:40960
    ds_read_b64_tr_b16 v[236:237], v195 offset:32768
    ds_read_b64_tr_b16 v[238:239], v195 offset:40960
    s_waitcnt lgkmcnt(6)
    v_mfma_f32_16x16x32_bf16 v[104:107], v[224:227], v[16:19], v[104:107]
    s_waitcnt lgkmcnt(4)
    v_mfma_f32_16x16x32_bf16 v[108:111], v[228:231], v[16:19], v[108:111]
    s_waitcnt lgkmcnt(2)
    v_mfma_f32_16x16x32_bf16 v[112:115], v[232:235], v[16:19], v[112:115]
    s_waitcnt lgkmcnt(0)
    v_mfma_f32_16x16x32_bf16 v[116:119], v[236:239], v[16:19], v[116:119]
    s_barrier
    buffer_load_dwordx4 v[96:99], v221, s[36:39], s34 offen sc1
    ds_read_b64_tr_b16 v[240:241], v192 offset:49152
    ds_read_b64_tr_b16 v[242:243], v192 offset:57344
    ds_read_b64_tr_b16 v[244:245], v193 offset:49152
    ds_read_b64_tr_b16 v[246:247], v193 offset:57344
    ds_read_b64_tr_b16 v[248:249], v194 offset:49152
    ds_read_b64_tr_b16 v[250:251], v194 offset:57344
    ds_read_b64_tr_b16 v[252:253], v195 offset:49152
    ds_read_b64_tr_b16 v[254:255], v195 offset:57344
    s_waitcnt lgkmcnt(6)
    v_mfma_f32_16x16x32_bf16 v[104:107], v[240:243], v[20:23], v[104:107]
    s_waitcnt lgkmcnt(4)
    v_mfma_f32_16x16x32_bf16 v[108:111], v[244:247], v[20:23], v[108:111]
    s_waitcnt lgkmcnt(2)
    v_mfma_f32_16x16x32_bf16 v[112:115], v[248:251], v[20:23], v[112:115]
    s_waitcnt lgkmcnt(0)
    v_mfma_f32_16x16x32_bf16 v[116:119], v[252:255], v[20:23], v[116:119]
    s_nop 3
    v_cndmask_b32 v104, v104, v108, s[8:9]
    v_cndmask_b32 v105, v105, v109, s[8:9]
    v_cndmask_b32 v106, v106, v110, s[8:9]
    v_cndmask_b32 v107, v107, v111, s[8:9]
    v_cndmask_b32 v104, v104, v112, s[10:11]
    v_cndmask_b32 v105, v105, v113, s[10:11]
    v_cndmask_b32 v106, v106, v114, s[10:11]
    v_cndmask_b32 v107, v107, v115, s[10:11]
    v_cndmask_b32 v104, v104, v116, s[12:13]
    v_cndmask_b32 v105, v105, v117, s[12:13]
    v_cndmask_b32 v106, v106, v118, s[12:13]
    v_cndmask_b32 v107, v107, v119, s[12:13]
    v_perm_b32 v104, v104, v198, s62
    v_perm_b32 v105, v105, v198, s63
    v_perm_b32 v106, v106, v198, s68
    v_perm_b32 v107, v107, v198, s69
    s_mov_b32 exec_lo, 0x00ff00ff
    s_mov_b32 exec_hi, 0x00ff00ff
    buffer_store_dwordx4 v[104:107], v219, s[36:39], s48 offen
    s_mov_b64 exec, -1
    s_mov_b32 s60, 0
    s_mov_b32 s59, 0
    s_mov_b32 s61, s34
    s_mov_b32 s46, s47
    buffer_load_dwordx4 v[8:11], v220, s[36:39], s61 offen sc1
    buffer_load_dwordx4 v[12:15], v220, s[36:39], s61 offen offset:128 sc1
    s_waitcnt vmcnt(3)
    v_perm_b32 v24, v97, v96, s66
    v_perm_b32 v25, v99, v98, s67
    v_or_b32 v24, v24, v25
    v_cmp_ne_u32 vcc, s46, v24
    s_nop 0
    s_cbranch_vccnz L_ml_23
L_mld_24:
    v_and_b32 v96, s51, v96
    v_and_b32 v98, s51, v98
    v_perm_b32 v97, v97, v197, s62
    v_perm_b32 v99, v99, v197, s62
    v_mov_b32 v24, v96
    v_mov_b32 v25, v98
    s_nop 1
    v_permlane32_swap_b32 v24, v25
    v_max_f32 v24, v24, v25
    v_mov_b32 v25, v24
    s_nop 1
    v_permlane16_swap_b32 v24, v25
    v_max_f32 v24, v24, v25
    s_nop 1
    v_max_f32_dpp v24, v24, v24 row_ror:8 row_mask:0xf bank_mask:0xf
    v_mov_b32 v25, v24
    s_nop 1
    v_permlane32_swap_b32 v24, v25
    v_sub_f32 v96, v96, v24
    v_sub_f32 v98, v98, v25
    v_mul_f32 v96, s65, v96
    v_mul_f32 v98, s65, v98
    v_exp_f32 v100, v96
    v_exp_f32 v102, v98
    v_mul_f32 v24, v97, v100
    v_mul_f32 v25, v99, v102
    s_nop 1
    v_permlane32_swap_b32 v24, v25
    v_add_f32 v24, v24, v25
    v_mov_b32 v25, v24
    s_nop 1
    v_permlane16_swap_b32 v24, v25
    v_add_f32 v24, v24, v25
    s_nop 1
    v_add_f32_dpp v24, v24, v24 row_ror:8 row_mask:0xf bank_mask:0xf
    v_rcp_f32 v24, v24
    s_nop 0
    v_mov_b32 v25, v24
    s_nop 1
    v_permlane32_swap_b32 v24, v25
    v_cndmask_b32 v100, v100, v102, s[14:15]
    v_cndmask_b32 v24, v24, v25, s[14:15]
    v_mul_f32 v100, v100, v24
    v_mov_b32 v101, v100
    buffer_load_dwordx4 v[8:11], v220, s[36:39], s61 offen sc1
    buffer_load_dwordx4 v[12:15], v220, s[36:39], s61 offen offset:128 sc1
L_op_26:
    s_waitcnt vmcnt(2)
    v_perm_b32 v24, v9, v8, s66
    v_perm_b32 v25, v11, v10, s67
    v_perm_b32 v26, v13, v12, s66
    v_perm_b32 v27, v15, v14, s67
    v_bitop3_b32 v24, v24, v25, s46 bitop3:0x96
    v_bitop3_b32 v26, v26, v27, s46 bitop3:0x96
    v_or_b32 v24, v24, v26
    v_cmp_ne_u32 vcc, 0, v24
    s_nop 0
    s_cbranch_vccz L_od_27
    s_wqm_b64 exec, vcc
    s_add_u32 s60, s60, 1
    s_cmp_ge_u32 s60, 60
    s_cbranch_scc1 L_os_28
    buffer_load_dwordx4 v[8:11], v220, s[36:39], s61 offen sc1
    buffer_load_dwordx4 v[12:15], v220, s[36:39], s61 offen offset:128 sc1
    s_branch L_op_26
L_od_27:
    s_mov_b64 exec, -1
    ds_read_b32 v1, v2 offset:0
    v_perm_b32 v24, v8, v197, s62
    v_perm_b32 v25, v9, v197, s62
    v_perm_b32 v28, v12, v197, s62
    v_perm_b32 v29, v13, v197, s62
    v_perm_b32 v26, v10, v197, s62
    v_perm_b32 v27, v11, v197, s62
    v_perm_b32 v30, v14, v197, s62
    v_perm_b32 v31, v15, v197, s62
    v_pk_mul_f32 v[24:25], v[24:25], v[100:101]
    v_pk_mul_f32 v[28:29], v[28:29], v[100:101]
    v_pk_mul_f32 v[26:27], v[26:27], v[100:101]
    v_pk_mul_f32 v[30:31], v[30:31], v[100:101]
    v_permlane32_swap_b32 v24, v28
    v_permlane32_swap_b32 v25, v29
    v_permlane32_swap_b32 v26, v30
    v_permlane32_swap_b32 v27, v31
    v_pk_add_f32 v[24:25], v[24:25], v[28:29]
    v_pk_add_f32 v[26:27], v[26:27], v[30:31]
    s_nop 0
    v_permlane16_swap_b32 v24, v25
    v_permlane16_swap_b32 v26, v27
    v_add_f32 v24, v24, v25
    v_add_f32 v26, v26, v27
    s_nop 0
    v_add_f32_dpp v24, v24, v24 row_ror:8 row_mask:0xf bank_mask:0xf
    v_add_f32_dpp v26, v26, v26 row_ror:8 row_mask:0xf bank_mask:0xf
    v_cndmask_b32 v24, v24, v26, s[54:55]
    s_waitcnt lgkmcnt(0)
    v_readfirstlane_b32 s56, v1
    v_mov_b32_dpp v25, v24 quad_perm:[2,3,0,1] row_mask:0xf bank_mask:0xf
    v_cvt_pk_bf16_f32 v24, v24, v25
    s_cmp_ge_u32 s56, 7
    s_cbranch_scc1 L_w1ok_29
L_spin_30:
    ds_read_b32 v1, v2 offset:0
    s_waitcnt lgkmcnt(0)
    v_readfirstlane_b32 s56, v1
    s_nop 0
    s_cmp_ge_u32 s56, 7
    s_cbranch_scc0 L_spin_30
L_w1ok_29:
    v_mov_b32_dpp v32, v24 row_newbcast:0 row_mask:0xf bank_mask:0xf
    v_mov_b32_dpp v33, v24 row_newbcast:4 row_mask:0xf bank_mask:0xf
    v_mov_b32_dpp v34, v24 row_newbcast:8 row_mask:0xf bank_mask:0xf
    v_mov_b32_dpp v35, v24 row_newbcast:12 row_mask:0xf bank_mask:0xf
    ds_read_b64_tr_b16 v[156:157], v200 offset:0
    ds_read_b64_tr_b16 v[158:159], v200 offset:1792
    v_mfma_f32_16x16x32_bf16 v[40:43], v[128:131], v[32:35], 0
    ds_read_b64_tr_b16 v[160:161], v201 offset:0
    ds_read_b64_tr_b16 v[162:163], v201 offset:1792
    v_mfma_f32_16x16x32_bf16 v[44:47], v[132:135], v[32:35], 0
    ds_read_b64_tr_b16 v[164:165], v202 offset:0
    ds_read_b64_tr_b16 v[166:167], v202 offset:1792
    v_mov_b32_dpp v36, v24 row_newbcast:1 row_mask:0xf bank_mask:0xf
    v_mfma_f32_16x16x32_bf16 v[48:51], v[136:139], v[32:35], 0
    ds_read_b64_tr_b16 v[168:169], v203 offset:0
    ds_read_b64_tr_b16 v[170:171], v203 offset:1792
    v_mov_b32_dpp v37, v24 row_newbcast:5 row_mask:0xf bank_mask:0xf
    v_mfma_f32_16x16x32_bf16 v[52:55], v[140:143], v[32:35], 0
    ds_read_b64_tr_b16 v[172:173], v204 offset:0
    ds_read_b64_tr_b16 v[174:175], v204 offset:1792
    v_mov_b32_dpp v38, v24 row_newbcast:9 row_mask:0xf bank_mask:0xf
    v_mfma_f32_16x16x32_bf16 v[56:59], v[144:147], v[32:35], 0
    ds_read_b64_tr_b16 v[176:177], v205 offset:0
    ds_read_b64_tr_b16 v[178:179], v205 offset:1792
    v_mov_b32_dpp v39, v24 row_newbcast:13 row_mask:0xf bank_mask:0xf
    v_mfma_f32_16x16x32_bf16 v[60:63], v[148:151], v[32:35], 0
    ds_read_b64_tr_b16 v[180:181], v206 offset:0
    ds_read_b64_tr_b16 v[182:183], v206 offset:1792
    v_mfma_f32_16x16x32_bf16 v[64:67], v[152:155], v[32:35], 0
    s_mov_b64 exec, 1
    ds_add_u32 v2, v3 offset:280
    s_mov_b64 exec, -1
    s_waitcnt lgkmcnt(13)
    v_mfma_f32_16x16x32_bf16 v[40:43], v[156:159], v[36:39], v[40:43]
    s_waitcnt lgkmcnt(11)
    v_mfma_f32_16x16x32_bf16 v[44:47], v[160:163], v[36:39], v[44:47]
    s_waitcnt lgkmcnt(9)
    v_mfma_f32_16x16x32_bf16 v[48:51], v[164:167], v[36:39], v[48:51]
    s_waitcnt lgkmcnt(7)
    v_mfma_f32_16x16x32_bf16 v[52:55], v[168:171], v[36:39], v[52:55]
    s_nop 3
    v_cndmask_b32 v40, v40, v44, s[16:17]
    v_cndmask_b32 v41, v41, v45, s[16:17]
    v_cndmask_b32 v42, v42, v46, s[16:17]
    v_cndmask_b32 v43, v43, v47, s[16:17]
    s_waitcnt lgkmcnt(5)
    v_mfma_f32_16x16x32_bf16 v[56:59], v[172:175], v[36:39], v[56:59]
    v_cndmask_b32 v40, v40, v48, s[18:19]
    v_cndmask_b32 v41, v41, v49, s[18:19]
    v_cndmask_b32 v42, v42, v50, s[18:19]
    v_cndmask_b32 v43, v43, v51, s[18:19]
    s_waitcnt lgkmcnt(3)
    v_mfma_f32_16x16x32_bf16 v[60:63], v[176:179], v[36:39], v[60:63]
    v_cndmask_b32 v40, v40, v52, s[20:21]
    v_cndmask_b32 v41, v41, v53, s[20:21]
    v_cndmask_b32 v42, v42, v54, s[20:21]
    v_cndmask_b32 v43, v43, v55, s[20:21]
    s_waitcnt lgkmcnt(1)
    v_mfma_f32_16x16x32_bf16 v[64:67], v[180:183], v[36:39], v[64:67]
    v_cndmask_b32 v40, v40, v56, s[22:23]
    v_cndmask_b32 v41, v41, v57, s[22:23]
    v_cndmask_b32 v42, v42, v58, s[22:23]
    v_cndmask_b32 v43, v43, v59, s[22:23]
    v_cndmask_b32 v40, v40, v60, s[24:25]
    v_cndmask_b32 v41, v41, v61, s[24:25]
    v_cndmask_b32 v42, v42, v62, s[24:25]
    v_cndmask_b32 v43, v43, v63, s[24:25]
    v_cndmask_b32 v40, v40, v64, s[26:27]
    v_cndmask_b32 v41, v41, v65, s[26:27]
    v_cndmask_b32 v42, v42, v66, s[26:27]
    v_cndmask_b32 v43, v43, v67, s[26:27]
    s_mov_b32 exec_lo, 0x00ff00ff
    s_mov_b32 exec_hi, 0x00ff00ff
    v_perm_b32 v40, v40, v199, s62
    v_perm_b32 v41, v41, v199, s63
    v_perm_b32 v42, v42, v199, s68
    v_perm_b32 v43, v43, v199, s69
    buffer_store_dwordx4 v[40:43], v207, s[36:39], s33 offen sc1
    s_endpgm
L_ml_23:
    s_wqm_b64 s[8:9], vcc
    s_add_u32 s60, s60, 1
    s_cmp_lt_u32 s60, 60
    s_cbranch_scc1 L_m2_32
    s_mov_b64 exec, -1
    s_cmp_eq_u32 s59, 0
    s_cbranch_scc0 L_sw_33
    s_mov_b32 s59, 1
    v_perm_b32 v104, v104, v199, s62
    v_perm_b32 v105, v105, v199, s63
    v_perm_b32 v106, v106, v199, s68
    v_perm_b32 v107, v107, v199, s69
    s_mov_b32 exec_lo, 0x00ff00ff
    s_mov_b32 exec_hi, 0x00ff00ff
    buffer_store_dwordx4 v[104:107], v219, s[36:39], s49 offen sc1
    s_cmp_lg_u32 s3, 0
    s_cbranch_scc1 L_sw_33
    s_mov_b64 exec, 0xff
    buffer_store_dwordx4 v[120:123], v124, s[36:39], s50 offen offset:2048 sc1
L_sw_33:
    s_add_u32 s56, s34, 1703936
    s_cmp_eq_u32 s61, s34
    s_cselect_b32 s61, s56, s34
    s_cselect_b32 s46, s32, s47
L_m2_32:
    s_mov_b64 exec, s[8:9]
    buffer_load_dwordx4 v[96:99], v221, s[36:39], s61 offen sc1
    s_mov_b64 exec, -1
    buffer_load_dwordx4 v[8:11], v220, s[36:39], s34 offen sc1
    buffer_load_dwordx4 v[12:15], v220, s[36:39], s34 offen offset:128 sc1
    s_mov_b64 exec, s[8:9]
    s_waitcnt vmcnt(2)
    v_perm_b32 v24, v97, v96, s66
    v_perm_b32 v25, v99, v98, s67
    v_or_b32 v24, v24, v25
    v_cmp_ne_u32 vcc, s46, v24
    s_cmp_lt_u32 s60, 4194304
    s_cselect_b64 vcc, vcc, 0
    s_cbranch_vccnz L_ml_23
    s_mov_b64 exec, -1
    s_mov_b32 s61, s34
    s_mov_b32 s46, s47
    s_branch L_mld_24
L_helper:
    s_mov_b64 exec, -1
    v_mov_b32 v2, 159744
    v_mov_b32 v4, 0
    v_mov_b32 v5, 0
    v_lshl_add_u32 v1, v0, 3, v2
    ds_write_b64 v1, v[4:5]
    v_mov_b32 v3, 1
    s_waitcnt lgkmcnt(0)
    s_barrier
    s_load_dword s32, s[26:27], 0
    s_lshl_b32 s99, s28, 2
    s_mul_i32 s100, s28, 3
    s_add_u32 s100, s100, 4
    s_min_u32 s99, s99, s100
    s_lshl_b32 s99, s99, 6
    s_cmp_lt_u32 s28, 4
    s_cselect_b32 s101, 32, 24
    s_mul_i32 s100, s101, s31
    s_add_u32 s100, s100, s99
    s_mov_b32 s36, s26
    s_mov_b32 s37, s27
    s_mov_b32 s38, 4194304
    s_mov_b32 s39, 0x20000
    s_mov_b32 s40, s4
    s_mov_b32 s41, s5
    s_mov_b32 s42, 3584
    s_mov_b32 s43, 0x20000
    s_mov_b32 s44, s22
    s_mov_b32 s45, s23
    s_mov_b32 s46, 3584
    s_mov_b32 s47, 0x20000
    s_mul_i32 s56, s30, 30720
    s_add_u32 s56, s56, 2752512
    s_lshl_b32 s57, s28, 11
    s_add_u32 s34, s56, s57
    s_lshl_b32 s57, s100, 2
    s_add_u32 s56, s56, s57
    s_add_u32 s48, s56, 16384
    v_lshlrev_b32 v5, 4, v0
    v_add_u32 v56, 122880, v5
    v_lshlrev_b32 v6, 3, v0
    v_add_u32 v7, 160256, v6
    s_lshr_b32 s56, s101, 2
    v_and_b32 v9, 7, v0
    v_cmp_gt_u32 s[54:55], s56, v9
    s_nop 0
    s_and_b32 s55, s55, 0
    v_lshlrev_b32 v46, 4, v9
    v_bfe_u32 v9, v0, 3, 1
    s_movk_i32 s56, 7168
    v_mad_u32_u24 v46, v9, s56, v46
    v_bfe_u32 v9, v0, 4, 1
    s_mov_b32 s56, 122880
    v_mad_u32_u24 v46, v9, s56, v46
    v_bfe_u32 v9, v0, 1, 1
    v_lshlrev_b32 v9, 5, v9
    v_and_b32 v1, 1, v0
    v_lshl_add_u32 v9, v1, 2, v9
    v_bfe_u32 v10, v0, 2, 1
    v_lshl_add_u32 v9, v10, 1, v9
    v_add_u32 v48, 160064, v9
    v_lshrrev_b32 v11, 4, v0
    v_lshlrev_b32 v49, 4, v11
    v_add_u32 v49, 160064, v49
    v_bfe_u32 v8, v0, 2, 1
    v_bfe_u32 v9, v0, 3, 1
    v_lshl_add_u32 v1, v8, 1, v9
    v_lshlrev_b32 v8, 2, v8
    v_add_u32 v8, v8, v9
    v_lshrrev_b32 v9, 5, v0
    v_lshl_add_u32 v8, v9, 1, v8
    v_bfe_u32 v9, v0, 4, 1
    v_lshl_add_u32 v8, v8, 2, v9
    v_and_b32 v9, 3, v0
    v_lshlrev_b32 v9, 3, v9
    s_movk_i32 s56, 896
    v_mad_u32_u24 v8, v8, s56, v9
    v_add_u32 v8, 131072, v8
    v_xor_b32 v12, 0, v1
    v_lshl_add_u32 v50, v12, 5, v8
    v_xor_b32 v12, 1, v1
    v_lshl_add_u32 v51, v12, 5, v8
    v_xor_b32 v12, 2, v1
    v_lshl_add_u32 v52, v12, 5, v8
    v_xor_b32 v12, 3, v1
    v_lshl_add_u32 v53, v12, 5, v8
    v_and_b32 v1, 1, v0
    v_and_b32 v9, 7, v0
    v_lshlrev_b32 v9, 4, v9
    v_lshl_add_u32 v9, v11, 7, v9
    v_bfe_u32 v10, v0, 3, 1
    v_lshl_add_u32 v54, v10, 9, v9
    s_and_b32 s56, s30, 1
    s_lshl_b32 s56, s56, 4
    s_lshl1_add_u32 s56, s28, s56
    s_lshr_b32 s57, s31, 2
    s_add_u32 s56, s56, s57
    s_lshl_b32 s56, s56, 1
    s_lshr_b32 s57, s30, 1
    s_xor_b32 s57, s57, 0
    s_add_u32 s56, s56, s57
    s_lshl_b32 s56, s56, 2
    s_and_b32 s57, s31, 3
    s_add_u32 s56, s56, s57
    s_lshl_b32 s56, s56, 11
    s_add_u32 s49, s56, 1572864
    v_mov_b32 v128, 0
    v_mov_b32 v129, 0
    v_mov_b32 v130, 0
    v_mov_b32 v131, 0
    v_mov_b32 v132, 0
    v_mov_b32 v133, 0
    v_mov_b32 v134, 0
    v_mov_b32 v135, 0
    v_mov_b32 v136, 0
    v_mov_b32 v137, 0
    v_mov_b32 v138, 0
    v_mov_b32 v139, 0
    v_mov_b32 v140, 0
    v_mov_b32 v141, 0
    v_mov_b32 v142, 0
    v_mov_b32 v143, 0
    v_mov_b32 v144, 0
    v_mov_b32 v145, 0
    v_mov_b32 v146, 0
    v_mov_b32 v147, 0
    v_mov_b32 v148, 0
    v_mov_b32 v149, 0
    v_mov_b32 v150, 0
    v_mov_b32 v151, 0
    v_mov_b32 v152, 0
    v_mov_b32 v153, 0
    v_mov_b32 v154, 0
    v_mov_b32 v155, 0
    v_mov_b32 v156, 0
    v_mov_b32 v157, 0
    v_mov_b32 v158, 0
    v_mov_b32 v159, 0
    v_mov_b32 v160, 0
    v_mov_b32 v161, 0
    v_mov_b32 v162, 0
    v_mov_b32 v163, 0
    v_mov_b32 v164, 0
    v_mov_b32 v165, 0
    v_mov_b32 v166, 0
    v_mov_b32 v167, 0
    v_mov_b32 v168, 0
    v_mov_b32 v169, 0
    v_mov_b32 v170, 0
    v_mov_b32 v171, 0
    v_mov_b32 v172, 0
    v_mov_b32 v173, 0
    v_mov_b32 v174, 0
    v_mov_b32 v175, 0
    v_mov_b32 v176, 0
    v_mov_b32 v177, 0
    v_mov_b32 v178, 0
    v_mov_b32 v179, 0
    v_mov_b32 v180, 0
    v_mov_b32 v181, 0
    v_mov_b32 v182, 0
    v_mov_b32 v183, 0
    s_lshr_b32 s35, s28, 1
    s_and_b32 s56, s28, 1
    s_lshl_b32 s56, s56, 3
    s_add_u32 s33, s56, s31
    v_lshrrev_b32 v10, 3, v0
    v_lshlrev_b32 v9, 4, v1
    v_lshl_add_u32 v41, v10, 14, v9
    v_bfe_u32 v10, v0, 1, 2
    v_lshl_add_u32 v41, v10, 11, v41
    v_lshrrev_b32 v10, 2, v0
    v_lshlrev_b32 v63, 14, v10
    v_and_b32 v10, 3, v0
    v_lshl_add_u32 v63, v10, 11, v63
    v_bfe_u32 v10, v0, 4, 1
    v_lshrrev_b32 v11, 5, v0
    v_lshl_add_u32 v10, v10, 1, v11
    v_lshl_add_u32 v10, v1, 4, v10
    s_lshr_b32 s56, s33, 2
    s_mul_i32 s56, s56, 112
    s_and_b32 s57, s33, 3
    s_lshl_b32 s57, s57, 2
    s_add_u32 s56, s56, s57
    s_lshl_b32 s57, s30, 5
    s_add_u32 s56, s56, s57
    s_mul_i32 s57, s35, 448
    s_add_u32 s56, s56, s57
    s_lshl_b32 s56, s56, 1
    v_lshl_add_u32 v43, v10, 1, s56
    s_cmp_eq_u32 s30, 3
    s_cselect_b32 s18, 0, 0x00020002
    s_or_b32 s18, s18, 0x00010001
    s_lshl_b32 s57, s33, 7
    s_lshl_b32 s56, s30, 5
    s_add_u32 s57, s57, s56
    s_and_b32 s56, s35, 1
    s_lshl_b32 s56, s56, 18
    s_add_u32 s57, s57, s56
    s_lshr_b32 s56, s35, 1
    s_xor_b32 s56, s56, 0
    s_lshl_b32 s56, s56, 13
    s_add_u32 s56, s56, s57
    s_add_u32 s14, s56, 1048576
    s_add_u32 s15, s14, 131072
    s_add_u32 s16, s56, 1572864
    s_add_u32 s17, s16, 131072
    s_mov_b32 s66, 0x0c0c0400
    s_mov_b32 s67, 0x04000c0c
    s_mov_b32 s62, 0x07060500
    s_mov_b32 s63, 0x07060501
    s_mov_b32 s68, 0x07060502
    s_mov_b32 s69, 0x07060503
    s_mov_b32 s64, 0xffff0000
    v_mov_b32 v42, 0x80
    s_mov_b32 s19, 0x05040100
    s_movk_i32 s96, 0x1000
    s_waitcnt lgkmcnt(0)
    s_mul_i32 s32, s32, 1664525
    s_add_u32 s32, s32, 1013904223
    v_mov_b32 v55, s32
    s_cmp_eq_u32 s2, 0
    s_cbranch_scc0 L_nopar
    s_cmp_eq_u32 s97, 0
    s_cselect_b32 s56, 8192, 0
    v_mov_b32 v8, s56
    v_perm_b32 v12, v8, v55, s62
    v_perm_b32 v13, v8, v55, s63
    v_perm_b32 v14, v8, v55, s68
    v_perm_b32 v15, v8, v55, s69
    s_mov_b64 exec, 0xff
    buffer_store_dwordx4 v[12:15], v5, s[36:39], s96 offen sc1
    s_mov_b64 exec, -1
L_nopar:
    s_lshr_b32 s56, s99, 6
    s_add_u32 s56, s56, s31
    s_sub_u32 s56, s56, 4
    s_bitcmp0_b32 s29, 1
    s_cselect_b32 s57, 64, 92
    s_add_u32 s56, s56, s57
    s_lshl_b32 s57, s28, 3
    s_lshr_b32 s58, s29, 1
    s_add_u32 s57, s57, s58
    s_cmp_lt_u32 s29, 16
    s_cselect_b32 s56, s57, s56
    s_lshl_b32 s56, s56, 8
    s_and_b32 s57, s29, 1
    s_mul_i32 s57, s57, 122880
    s_add_u32 s56, s56, s57
    s_add_u32 s50, s56, 2752512
    s_add_u32 s51, s56, 3014656
    v_lshrrev_b32 v8, 4, v0
    s_movk_i32 s57, 30720
    v_and_b32 v9, 15, v0
    v_lshlrev_b32 v9, 4, v9
    v_mad_u32_u24 v59, v8, s57, v9
    v_add_u32 v60, 161280, v5
    v_mov_b32 v196, 0x7ff00000
L_spin_34:
    ds_read_b32 v1, v2 offset:256
    s_waitcnt lgkmcnt(0)
    v_readfirstlane_b32 s56, v1
    s_nop 0
    s_cmp_ge_u32 s56, 4
    s_cbranch_scc0 L_spin_34
    s_and_b32 s56, s28, 4
    s_add_u32 s56, s56, s29
    s_cmp_lt_u32 s56, 32
    s_cbranch_scc0 L_nopj
    ds_read_b128 v[192:195], v60
    s_waitcnt lgkmcnt(0)
    v_perm_b32 v192, v192, v55, s62
    v_perm_b32 v193, v193, v55, s63
    v_perm_b32 v194, v194, v55, s68
    v_perm_b32 v195, v195, v55, s69
    buffer_store_dwordx4 v[192:195], v59, s[36:39], s50 offen
    v_mov_b32 v196, v59
L_nopj:
    s_sub_u32 s48, s48, s34
    v_add_u32 v46, s48, v46
    s_mov_b64 s[6:7], -1
    s_mov_b64 s[8:9], -1
    s_mov_b64 s[10:11], -1
    s_mov_b64 s[12:13], -1
    s_mov_b64 s[20:21], s[54:55]
    s_mov_b64 s[24:25], 15
    v_mov_b32 v24, 0
    v_mov_b32 v25, 0
    v_mov_b32 v26, 0
    v_mov_b32 v27, 0
    s_mov_b32 s60, 0
    s_mov_b32 s61, s34
    s_mov_b64 exec, s[6:7]
    buffer_load_dwordx4 v[8:11], v5, s[36:39], s61 offen offset:0 sc1
    s_mov_b64 exec, s[8:9]
    buffer_load_dwordx4 v[12:15], v5, s[36:39], s61 offen offset:1024 sc1
    s_mov_b64 exec, s[10:11]
    buffer_load_dwordx4 v[16:19], v56, s[36:39], s61 offen offset:0 sc1
    s_mov_b64 exec, s[12:13]
    buffer_load_dwordx4 v[20:23], v56, s[36:39], s61 offen offset:1024 sc1
    s_mov_b64 exec, s[20:21]
    buffer_load_dwordx4 v[24:27], v46, s[36:39], s61 offen offset:0 sc1
    s_mov_b64 exec, s[24:25]
    buffer_load_dwordx4 v[28:31], v5, s[36:39], s96 offen sc1
    s_mov_b64 exec, -1
L_spin_39:
    ds_read_b32 v1, v2 offset:0
    s_waitcnt lgkmcnt(0)
    v_readfirstlane_b32 s56, v1
    s_nop 0
    s_cmp_ge_u32 s56, 1
    s_cbranch_scc1 L_spind_40
    s_sleep 1
    s_branch L_spin_39
L_spind_40:
L_fp_36:
    s_mov_b64 exec, s[6:7]
    buffer_load_dwordx4 v[8:11], v5, s[36:39], s61 offen offset:0 sc1
    s_mov_b64 exec, s[8:9]
    buffer_load_dwordx4 v[12:15], v5, s[36:39], s61 offen offset:1024 sc1
    s_mov_b64 exec, s[10:11]
    buffer_load_dwordx4 v[16:19], v56, s[36:39], s61 offen offset:0 sc1
    s_mov_b64 exec, s[12:13]
    buffer_load_dwordx4 v[20:23], v56, s[36:39], s61 offen offset:1024 sc1
    s_mov_b64 exec, s[20:21]
    buffer_load_dwordx4 v[24:27], v46, s[36:39], s61 offen offset:0 sc1
    s_mov_b64 exec, s[24:25]
    buffer_load_dwordx4 v[28:31], v5, s[36:39], s96 offen sc1
    s_mov_b64 exec, -1
    s_waitcnt vmcnt(6)
    v_perm_b32 v61, v9, v8, s66
    v_perm_b32 v62, v11, v10, s67
    v_or_b32 v61, v61, v62
    v_cmp_ne_u32 s[6:7], s32, v61
    v_perm_b32 v1, v13, v12, s66
    v_perm_b32 v4, v15, v14, s67
    v_or_b32 v1, v1, v4
    v_cmp_ne_u32 s[8:9], s32, v1
    v_perm_b32 v61, v17, v16, s66
    v_perm_b32 v62, v19, v18, s67
    v_or_b32 v61, v61, v62
    v_cmp_ne_u32 s[10:11], s32, v61
    v_perm_b32 v1, v21, v20, s66
    v_perm_b32 v4, v23, v22, s67
    v_or_b32 v1, v1, v4
    v_cmp_ne_u32 s[12:13], s32, v1
    v_perm_b32 v61, v25, v24, s66
    v_perm_b32 v62, v27, v26, s67
    v_or_b32 v61, v61, v62
    v_cmp_ne_u32 s[20:21], s32, v61
    v_perm_b32 v1, v29, v28, s66
    v_perm_b32 v4, v31, v30, s67
    v_or_b32 v1, v1, v4
    v_cmp_ne_u32 s[24:25], s32, v1
    s_wqm_b64 s[6:7], s[6:7]
    s_and_b64 s[20:21], s[20:21], s[54:55]
    s_wqm_b64 s[8:9], s[8:9]
    s_wqm_b64 s[10:11], s[10:11]
    s_wqm_b64 s[12:13], s[12:13]
    s_wqm_b64 s[20:21], s[20:21]
    s_or_b64 s[52:53], s[6:7], s[8:9]
    s_and_b64 s[20:21], s[20:21], s[54:55]
    s_and_b64 s[24:25], s[24:25], 15
    s_wqm_b64 s[24:25], s[24:25]
    s_or_b64 s[52:53], s[52:53], s[10:11]
    s_or_b64 s[52:53], s[52:53], s[12:13]
    s_or_b64 s[52:53], s[52:53], s[20:21]
    s_or_b64 s[52:53], s[52:53], s[24:25]
    s_cbranch_scc0 L_fpd_37
    s_add_u32 s60, s60, 1
    s_cmp_lt_u32 s60, 12
    s_cbranch_scc1 L_fp_36
    s_branch L_fps_38
L_fpd_37:
    s_mov_b64 exec, -1
    v_perm_b32 v64, v8, v42, s62
    v_perm_b32 v65, v9, v42, s62
    v_perm_b32 v66, v10, v42, s62
    v_perm_b32 v67, v11, v42, s62
    v_perm_b32 v68, v12, v42, s62
    v_perm_b32 v69, v13, v42, s62
    v_perm_b32 v70, v14, v42, s62
    v_perm_b32 v71, v15, v42, s62
    v_perm_b32 v72, v16, v42, s62
    v_perm_b32 v73, v17, v42, s62
    v_perm_b32 v74, v18, v42, s62
    v_perm_b32 v75, v19, v42, s62
    v_perm_b32 v76, v20, v42, s62
    v_perm_b32 v77, v21, v42, s62
    v_perm_b32 v78, v22, v42, s62
    v_perm_b32 v79, v23, v42, s62
    v_perm_b32 v80, v24, v42, s62
    v_perm_b32 v81, v25, v42, s62
    v_perm_b32 v82, v26, v42, s62
    v_perm_b32 v83, v27, v42, s62
    v_pk_add_f32 v[64:65], v[64:65], v[72:73]
    v_pk_add_f32 v[66:67], v[66:67], v[74:75]
    v_pk_add_f32 v[68:69], v[68:69], v[76:77]
    v_pk_add_f32 v[70:71], v[70:71], v[78:79]
    v_cvt_pk_bf16_f32 v72, v64, v65
    v_cvt_pk_bf16_f32 v73, v66, v67
    v_cvt_pk_bf16_f32 v74, v68, v69
    v_cvt_pk_bf16_f32 v75, v70, v71
    v_readfirstlane_b32 s56, v28
    s_nop 0
    s_and_b32 s56, s56, 8192
    v_mov_b32 v1, s56
    ds_write_b32 v2, v1 offset:288
    s_xor_b32 s14, s14, s56
    s_xor_b32 s15, s15, s56
    s_xor_b32 s16, s16, s56
    s_xor_b32 s17, s17, s56
    s_xor_b32 s49, s49, s56
    ds_write_b64 v7, v[72:73]
    ds_write_b64 v7, v[74:75] offset:512
    s_waitcnt lgkmcnt(0)
    s_mov_b64 exec, 1
    ds_add_u32 v2, v3 offset:260
    s_mov_b64 exec, -1
    buffer_load_ushort v44, v43, s[40:43], 0 offen
    buffer_load_dword v40, v63, s[36:39], s14 offen
    v_mov_b32 v84, v80
    v_mov_b32 v85, v81
    v_mov_b32 v86, v82
    v_mov_b32 v87, v83
    v_permlane16_swap_b32 v80, v84
    v_permlane16_swap_b32 v81, v85
    v_permlane16_swap_b32 v82, v86
    v_permlane16_swap_b32 v83, v87
    v_pk_add_f32 v[80:81], v[80:81], v[84:85]
    v_pk_add_f32 v[82:83], v[82:83], v[86:87]
    v_cvt_pk_bf16_f32 v72, v80, v81
    v_cvt_pk_bf16_f32 v73, v82, v83
    s_nop 0
    v_mov_b32_dpp v74, v72 row_ror:8 row_mask:0xf bank_mask:0xf
    v_mov_b32_dpp v75, v73 row_ror:8 row_mask:0xf bank_mask:0xf
    v_lshlrev_b32 v64, 16, v72
    v_and_b32 v65, s64, v72
    v_lshlrev_b32 v66, 16, v73
    v_and_b32 v67, s64, v73
    v_lshlrev_b32 v68, 16, v74
    v_and_b32 v69, s64, v74
    v_lshlrev_b32 v70, 16, v75
    v_and_b32 v71, s64, v75
    v_cmp_lt_f32 s[6:7], 0, v64
    v_cmp_lt_f32 s[8:9], 0, v65
    v_cmp_lt_f32 s[10:11], 0, v66
    v_cmp_lt_f32 s[12:13], 0, v67
    v_cndmask_b32 v72, 0, 1.0, s[6:7]
    v_cndmask_b32 v73, 0, 1.0, s[8:9]
    v_cndmask_b32 v74, 0, 1.0, s[10:11]
    v_cndmask_b32 v75, 0, 1.0, s[12:13]
    v_pk_mul_f32 v[64:65], v[64:65], v[72:73]
    v_pk_mul_f32 v[66:67], v[66:67], v[74:75]
    v_pk_mul_f32 v[64:65], v[64:65], v[68:69]
    v_pk_mul_f32 v[66:67], v[66:67], v[70:71]
    v_cvt_pk_bf16_f32 v68, v64, v65
    v_cvt_pk_bf16_f32 v69, v66, v67
    s_mov_b64 exec, 0xff
    ds_write_b16 v48, v68
    ds_write_b16_d16_hi v48, v68 offset:16
    ds_write_b16 v48, v69 offset:8
    ds_write_b16_d16_hi v48, v69 offset:24
    s_waitcnt lgkmcnt(0)
    s_mov_b32 exec_lo, 0x10001
    s_mov_b32 exec_hi, 0x10001
    ds_read_b128 v[128:131], v49
    s_mov_b32 exec_lo, 0x20002
    s_mov_b32 exec_hi, 0x20002
    ds_read_b128 v[132:135], v49
    s_mov_b32 exec_lo, 0x40004
    s_mov_b32 exec_hi, 0x40004
    ds_read_b128 v[136:139], v49
    s_mov_b32 exec_lo, 0x80008
    s_mov_b32 exec_hi, 0x80008
    ds_read_b128 v[140:143], v49
    s_mov_b32 exec_lo, 0x100010
    s_mov_b32 exec_hi, 0x100010
    ds_read_b128 v[144:147], v49
    s_mov_b32 exec_lo, 0x200020
    s_mov_b32 exec_hi, 0x200020
    ds_read_b128 v[148:151], v49
    s_mov_b32 exec_lo, 0x400040
    s_mov_b32 exec_hi, 0x400040
    ds_read_b128 v[152:155], v49
    s_mov_b32 exec_lo, 0x1000100
    s_mov_b32 exec_hi, 0x1000100
    ds_read_b128 v[156:159], v49
    s_mov_b32 exec_lo, 0x2000200
    s_mov_b32 exec_hi, 0x2000200
    ds_read_b128 v[160:163], v49
    s_mov_b32 exec_lo, 0x4000400
    s_mov_b32 exec_hi, 0x4000400
    ds_read_b128 v[164:167], v49
    s_mov_b32 exec_lo, 0x8000800
    s_mov_b32 exec_hi, 0x8000800
    ds_read_b128 v[168:171], v49
    s_mov_b32 exec_lo, 0x10001000
    s_mov_b32 exec_hi, 0x10001000
    ds_read_b128 v[172:175], v49
    s_mov_b32 exec_lo, 0x20002000
    s_mov_b32 exec_hi, 0x20002000
    ds_read_b128 v[176:179], v49
    s_mov_b32 exec_lo, 0x40004000
    s_mov_b32 exec_hi, 0x40004000
    ds_read_b128 v[180:183], v49
    s_mov_b64 exec, -1
L_spin_41:
    ds_read_b32 v1, v2 offset:0
    s_waitcnt lgkmcnt(0)
    v_readfirstlane_b32 s56, v1
    s_nop 0
    s_cmp_ge_u32 s56, 2
    s_cbranch_scc1 L_spind_42
    s_sleep 1
    s_branch L_spin_41
L_spind_42:
    ds_read_b64_tr_b16 v[64:65], v50 offset:0
    ds_read_b64_tr_b16 v[66:67], v50 offset:1792
    ds_read_b64_tr_b16 v[68:69], v51 offset:0
    ds_read_b64_tr_b16 v[70:71], v51 offset:1792
    ds_read_b64_tr_b16 v[72:73], v52 offset:0
    ds_read_b64_tr_b16 v[74:75], v52 offset:1792
    ds_read_b64_tr_b16 v[76:77], v53 offset:0
    ds_read_b64_tr_b16 v[78:79], v53 offset:1792
    ds_read_b64_tr_b16 v[80:81], v50 offset:128
    ds_read_b64_tr_b16 v[82:83], v50 offset:1920
    ds_read_b64_tr_b16 v[84:85], v51 offset:128
    ds_read_b64_tr_b16 v[86:87], v51 offset:1920
    ds_read_b64_tr_b16 v[88:89], v52 offset:128
    ds_read_b64_tr_b16 v[90:91], v52 offset:1920
    s_waitcnt lgkmcnt(12)
    v_mfma_f32_16x16x32_bf16 v[56:59], v[64:67], v[128:131], 0
    ds_read_b64_tr_b16 v[92:93], v53 offset:128
    ds_read_b64_tr_b16 v[94:95], v53 offset:1920
    s_waitcnt lgkmcnt(12)
    v_mfma_f32_16x16x32_bf16 v[56:59], v[68:71], v[132:135], v[56:59]
    ds_read_b64_tr_b16 v[96:97], v50 offset:256
    ds_read_b64_tr_b16 v[98:99], v50 offset:2048
    s_waitcnt lgkmcnt(12)
    v_mfma_f32_16x16x32_bf16 v[56:59], v[72:75], v[136:139], v[56:59]
    ds_read_b64_tr_b16 v[100:101], v51 offset:256
    ds_read_b64_tr_b16 v[102:103], v51 offset:2048
    s_waitcnt lgkmcnt(12)
    v_mfma_f32_16x16x32_bf16 v[56:59], v[76:79], v[140:143], v[56:59]
    ds_read_b64_tr_b16 v[104:105], v52 offset:256
    ds_read_b64_tr_b16 v[106:107], v52 offset:2048
    s_waitcnt lgkmcnt(12)
    v_mfma_f32_16x16x32_bf16 v[56:59], v[80:83], v[144:147], v[56:59]
    ds_read_b64_tr_b16 v[108:109], v53 offset:256
    ds_read_b64_tr_b16 v[110:111], v53 offset:2048
    s_waitcnt lgkmcnt(12)
    v_mfma_f32_16x16x32_bf16 v[56:59], v[84:87], v[148:151], v[56:59]
    ds_read_b64_tr_b16 v[112:113], v50 offset:384
    ds_read_b64_tr_b16 v[114:115], v50 offset:2176
    s_waitcnt lgkmcnt(12)
    v_mfma_f32_16x16x32_bf16 v[56:59], v[88:91], v[152:155], v[56:59]
    ds_read_b64_tr_b16 v[116:117], v51 offset:384
    ds_read_b64_tr_b16 v[118:119], v51 offset:2176
    s_waitcnt lgkmcnt(12)
    v_mfma_f32_16x16x32_bf16 v[56:59], v[92:95], v[156:159], v[56:59]
    ds_read_b64_tr_b16 v[64:65], v52 offset:384
    ds_read_b64_tr_b16 v[66:67], v52 offset:2176
    s_waitcnt lgkmcnt(12)
    v_mfma_f32_16x16x32_bf16 v[56:59], v[96:99], v[160:163], v[56:59]
    ds_read_b64_tr_b16 v[68:69], v53 offset:384
    ds_read_b64_tr_b16 v[70:71], v53 offset:2176
    s_waitcnt lgkmcnt(12)
    v_mfma_f32_16x16x32_bf16 v[56:59], v[100:103], v[164:167], v[56:59]
    ds_read_b64_tr_b16 v[72:73], v50 offset:512
    ds_read_b64_tr_b16 v[74:75], v50 offset:2304
    s_waitcnt lgkmcnt(12)
    v_mfma_f32_16x16x32_bf16 v[56:59], v[104:107], v[168:171], v[56:59]
    ds_read_b64_tr_b16 v[76:77], v51 offset:512
    ds_read_b64_tr_b16 v[78:79], v51 offset:2304
    s_waitcnt lgkmcnt(12)
    v_mfma_f32_16x16x32_bf16 v[56:59], v[108:111], v[172:175], v[56:59]
    ds_read_b64_tr_b16 v[80:81], v52 offset:512
    ds_read_b64_tr_b16 v[82:83], v52 offset:2304
    s_waitcnt lgkmcnt(12)
    v_mfma_f32_16x16x32_bf16 v[56:59], v[112:115], v[176:179], v[56:59]
    ds_read_b64_tr_b16 v[84:85], v53 offset:512
    ds_read_b64_tr_b16 v[86:87], v53 offset:2304
    s_waitcnt lgkmcnt(12)
    v_mfma_f32_16x16x32_bf16 v[56:59], v[116:119], v[180:183], v[56:59]
    ds_read_b64_tr_b16 v[88:89], v50 offset:640
    ds_read_b64_tr_b16 v[90:91], v50 offset:2432
    s_waitcnt lgkmcnt(12)
    v_mfma_f32_16x16x32_bf16 v[60:63], v[64:67], v[128:131], 0
    ds_read_b64_tr_b16 v[92:93], v51 offset:640
    ds_read_b64_tr_b16 v[94:95], v51 offset:2432
    s_waitcnt lgkmcnt(12)
    v_mfma_f32_16x16x32_bf16 v[60:63], v[68:71], v[132:135], v[60:63]
    ds_read_b64_tr_b16 v[96:97], v52 offset:640
    ds_read_b64_tr_b16 v[98:99], v52 offset:2432
    s_waitcnt lgkmcnt(12)
    v_mfma_f32_16x16x32_bf16 v[60:63], v[72:75], v[136:139], v[60:63]
    ds_read_b64_tr_b16 v[100:101], v53 offset:640
    ds_read_b64_tr_b16 v[102:103], v53 offset:2432
    s_waitcnt lgkmcnt(12)
    v_mfma_f32_16x16x32_bf16 v[60:63], v[76:79], v[140:143], v[60:63]
    ds_read_b64_tr_b16 v[104:105], v50 offset:768
    ds_read_b64_tr_b16 v[106:107], v50 offset:2560
    s_waitcnt lgkmcnt(12)
    v_mfma_f32_16x16x32_bf16 v[60:63], v[80:83], v[144:147], v[60:63]
    ds_read_b64_tr_b16 v[108:109], v51 offset:768
    ds_read_b64_tr_b16 v[110:111], v51 offset:2560
    s_waitcnt lgkmcnt(12)
    v_mfma_f32_16x16x32_bf16 v[60:63], v[84:87], v[148:151], v[60:63]
    ds_read_b64_tr_b16 v[112:113], v52 offset:768
    ds_read_b64_tr_b16 v[114:115], v52 offset:2560
    s_waitcnt lgkmcnt(12)
    v_mfma_f32_16x16x32_bf16 v[60:63], v[88:91], v[152:155], v[60:63]
    ds_read_b64_tr_b16 v[116:117], v53 offset:768
    ds_read_b64_tr_b16 v[118:119], v53 offset:2560
    s_waitcnt lgkmcnt(12)
    v_mfma_f32_16x16x32_bf16 v[60:63], v[92:95], v[156:159], v[60:63]
    s_waitcnt lgkmcnt(10)
    v_mfma_f32_16x16x32_bf16 v[60:63], v[96:99], v[160:163], v[60:63]
    s_waitcnt lgkmcnt(8)
    v_mfma_f32_16x16x32_bf16 v[60:63], v[100:103], v[164:167], v[60:63]
    s_waitcnt lgkmcnt(6)
    v_mfma_f32_16x16x32_bf16 v[60:63], v[104:107], v[168:171], v[60:63]
    s_waitcnt lgkmcnt(4)
    v_mfma_f32_16x16x32_bf16 v[60:63], v[108:111], v[172:175], v[60:63]
    s_waitcnt lgkmcnt(2)
    v_mfma_f32_16x16x32_bf16 v[60:63], v[112:115], v[176:179], v[60:63]
    s_waitcnt lgkmcnt(0)
    v_mfma_f32_16x16x32_bf16 v[60:63], v[116:119], v[180:183], v[60:63]
    v_perm_b32 v56, v56, v55, s62
    v_perm_b32 v57, v57, v55, s63
    v_perm_b32 v58, v58, v55, s68
    v_perm_b32 v59, v59, v55, s69
    s_nop 3
    v_perm_b32 v60, v60, v55, s62
    v_perm_b32 v61, v61, v55, s63
    v_perm_b32 v62, v62, v55, s68
    v_perm_b32 v63, v63, v55, s69
L_spin_43:
    ds_read_b32 v1, v2 offset:0
    s_waitcnt lgkmcnt(0)
    v_readfirstlane_b32 s56, v1
    s_nop 0
    s_cmp_ge_u32 s56, 4
    s_cbranch_scc1 L_spind_44
    s_sleep 2
    s_branch L_spin_43
L_spind_44:
    buffer_store_dwordx4 v[56:59], v54, s[36:39], s49 offen sc1
    buffer_store_dwordx4 v[60:63], v54, s[36:39], s49 offen offset:1024 sc1
    s_barrier
    s_waitcnt vmcnt(2)
    s_getreg_b32 s56, hwreg(HW_REG_XCC_ID)
    s_and_b32 s56, s56, 15
    s_add_u32 s56, s56, 1
    s_mul_i32 s56, s56, 0x9e3779b1
    s_xor_b32 s53, s32, s56
    v_lshrrev_b32 v8, 4, v0
    v_bfe_u32 v9, v0, 1, 3
    v_lshl_add_u32 v8, v8, 6, v9
    s_movk_i32 s56, 2176
    v_and_b32 v9, 1, v0
    v_lshlrev_b32 v9, 4, v9
    v_mad_u32_u24 v8, v8, s56, v9
    s_mul_i32 s57, s28, 17408
    s_add_u32 s57, s57, 395264
    s_mov_b32 s60, 12
L_sk_45:
    buffer_load_dwordx4 v[12:15], v8, s[36:39], s57 offen sc1
    s_waitcnt vmcnt(0)
    v_perm_b32 v1, v13, v12, s66
    v_perm_b32 v4, v15, v14, s67
    v_or_b32 v1, v1, v4
    v_cmp_ne_u32 vcc, s53, v1
    s_nop 0
    s_cbranch_vccz L_skd_46
    s_wqm_b64 exec, vcc
    s_sleep 4
    s_sub_u32 s60, s60, 1
    s_cbranch_scc0 L_sk_45
    s_mov_b64 exec, -1
    buffer_store_dwordx4 v[192:195], v196, s[36:39], s51 offen sc1
L_skd_46:
    s_mov_b64 exec, -1
L_spin_51:
    ds_read_b32 v1, v2 offset:280
    s_waitcnt lgkmcnt(0)
    v_readfirstlane_b32 s56, v1
    s_nop 0
    s_cmp_ge_u32 s56, 4
    s_cbranch_scc0 L_spin_51
    s_mov_b32 s60, 4194304
L_fy_47:
    buffer_load_dwordx4 v[16:19], v41, s[36:39], s16 offen sc1
    buffer_load_dwordx4 v[20:23], v41, s[36:39], s17 offen sc1
    s_waitcnt vmcnt(0)
    v_perm_b32 v1, v17, v16, s66
    v_perm_b32 v4, v19, v18, s67
    v_perm_b32 v46, v21, v20, s66
    v_perm_b32 v47, v23, v22, s67
    v_bitop3_b32 v1, v1, v4, s32 bitop3:0x96
    v_bitop3_b32 v46, v46, v47, s32 bitop3:0x96
    v_or_b32 v1, v1, v46
    v_cmp_ne_u32 vcc, 0, v1
    s_nop 0
    s_cbranch_vccz L_fys_48
    s_wqm_b64 exec, vcc
    s_sub_u32 s60, s60, 1
    s_cbranch_scc0 L_fy_47
L_fys_48:
    s_mov_b64 exec, -1
    v_perm_b32 v16, v16, v42, s62
    v_perm_b32 v17, v17, v42, s62
    v_perm_b32 v18, v18, v42, s62
    v_perm_b32 v19, v19, v42, s62
    v_perm_b32 v20, v20, v42, s62
    v_perm_b32 v21, v21, v42, s62
    v_perm_b32 v22, v22, v42, s62
    v_perm_b32 v23, v23, v42, s62
    v_pk_add_f32 v[16:17], v[16:17], v[20:21]
    v_pk_add_f32 v[18:19], v[18:19], v[22:23]
    s_nop 0
    v_permlane32_swap_b32 v16, v17
    v_permlane32_swap_b32 v18, v19
    v_add_f32 v16, v16, v17
    v_add_f32 v18, v18, v19
    s_nop 1
    v_permlane16_swap_b32 v16, v18
    v_add_f32 v16, v16, v18
    s_nop 1
    v_add_f32_dpp v16, v16, v16 row_ror:2 row_mask:0xf bank_mask:0xf
    s_nop 1
    v_add_f32_dpp v16, v16, v16 row_ror:4 row_mask:0xf bank_mask:0xf
    s_nop 1
    v_add_f32_dpp v16, v16, v16 row_ror:8 row_mask:0xf bank_mask:0xf
    v_cvt_pk_bf16_f32 v16, v16, v16
    v_and_b32 v16, s64, v16
    v_mul_f32 v17, 0xbfb8aa3b, v16
    v_exp_f32 v17, v17
    s_nop 0
    v_add_f32 v17, 1.0, v17
    v_rcp_f32 v17, v17
    s_nop 0
    v_mul_f32 v16, v16, v17
    v_cvt_pk_bf16_f32 v16, v16, v16
    v_and_b32 v45, s64, v16
    v_lshlrev_b32 v44, 16, v44
    buffer_load_dwordx4 v[8:11], v41, s[36:39], s14 offen sc1
    buffer_load_dwordx4 v[12:15], v41, s[36:39], s15 offen sc1
    s_waitcnt vmcnt(0)
    v_perm_b32 v1, v9, v8, s66
    v_perm_b32 v4, v11, v10, s67
    v_perm_b32 v46, v13, v12, s66
    v_perm_b32 v47, v15, v14, s67
    v_bitop3_b32 v1, v1, v4, s32 bitop3:0x96
    v_bitop3_b32 v46, v46, v47, s32 bitop3:0x96
    v_or_b32 v1, v1, v46
    v_cmp_ne_u32 vcc, 0, v1
    s_nop 0
    s_cbranch_vccz L_fd_50
    s_wqm_b64 exec, vcc
    buffer_load_dwordx4 v[8:11], v41, s[36:39], s14 offen sc1
    buffer_load_dwordx4 v[12:15], v41, s[36:39], s15 offen sc1
    buffer_load_dwordx4 v[8:11], v41, s[36:39], s14 offen sc1
    buffer_load_dwordx4 v[12:15], v41, s[36:39], s15 offen sc1
L_fs_49:
    s_waitcnt vmcnt(2)
    v_perm_b32 v1, v9, v8, s66
    v_perm_b32 v4, v11, v10, s67
    v_perm_b32 v46, v13, v12, s66
    v_perm_b32 v47, v15, v14, s67
    v_bitop3_b32 v1, v1, v4, s32 bitop3:0x96
    v_bitop3_b32 v46, v46, v47, s32 bitop3:0x96
    v_or_b32 v1, v1, v46
    v_cmp_ne_u32 vcc, 0, v1
    s_nop 0
    s_cbranch_vccz L_fd_50
    s_wqm_b64 exec, vcc
    buffer_load_dwordx4 v[8:11], v41, s[36:39], s14 offen sc1
    buffer_load_dwordx4 v[12:15], v41, s[36:39], s15 offen sc1
    s_sub_u32 s60, s60, 1
    s_cbranch_scc0 L_fs_49
    s_waitcnt vmcnt(0)
L_fd_50:
    s_mov_b64 exec, -1
    v_perm_b32 v24, v8, v42, s62
    v_perm_b32 v25, v9, v42, s62
    v_perm_b32 v26, v10, v42, s62
    v_perm_b32 v27, v11, v42, s62
    v_perm_b32 v28, v12, v42, s62
    v_perm_b32 v29, v13, v42, s62
    v_perm_b32 v30, v14, v42, s62
    v_perm_b32 v31, v15, v42, s62
    v_pk_add_f32 v[24:25], v[24:25], v[28:29]
    v_pk_add_f32 v[26:27], v[26:27], v[30:31]
    s_nop 0
    v_permlane32_swap_b32 v24, v25
    v_permlane32_swap_b32 v26, v27
    v_add_f32 v24, v24, v25
    v_add_f32 v26, v26, v27
    s_nop 1
    v_permlane16_swap_b32 v24, v26
    v_add_f32 v24, v24, v26
    s_nop 1
    v_add_f32_dpp v24, v24, v24 row_ror:2 row_mask:0xf bank_mask:0xf
    s_nop 1
    v_add_f32_dpp v24, v24, v24 row_ror:4 row_mask:0xf bank_mask:0xf
    s_nop 1
    v_add_f32_dpp v24, v24, v24 row_ror:8 row_mask:0xf bank_mask:0xf
    v_cvt_pk_bf16_f32 v24, v24, v24
    v_and_b32 v24, s64, v24
    v_mul_f32 v24, v24, v45
    v_cvt_pk_bf16_f32 v24, v24, v24
    v_and_b32 v24, s64, v24
    v_add_f32 v24, v24, v44
    v_cvt_pk_bf16_f32 v24, v24, v24
    s_mov_b32 exec_lo, s18
    s_mov_b32 exec_hi, s18
    buffer_store_short v24, v43, s[44:47], 0 offen
    s_endpgm
L_epoch:
    s_mov_b64 exec, -1
    s_setprio 0
    s_load_dword s32, s[26:27], 0
    s_mov_b32 s36, s26
    s_mov_b32 s37, s27
    s_mov_b32 s38, 4194304
    s_mov_b32 s39, 0x20000
    s_mov_b32 s66, 0x0c0c0400
    s_mov_b32 s67, 0x04000c0c
    s_waitcnt lgkmcnt(0)
    s_mul_i32 s32, s32, 1664525
    s_add_u32 s32, s32, 1013904223
    v_mov_b32 v2, 159744
L_spin_53:
    ds_read_b32 v1, v2 offset:280
    s_waitcnt lgkmcnt(0)
    v_readfirstlane_b32 s56, v1
    s_nop 0
    s_cmp_ge_u32 s56, 4
    s_cbranch_scc1 L_spind_54
    s_sleep 1
    s_branch L_spin_53
L_spind_54:
    v_lshrrev_b32 v6, 2, v0
    v_lshlrev_b32 v5, 14, v6
    v_and_b32 v6, 3, v0
    v_lshl_add_u32 v5, v6, 11, v5
    s_mov_b32 s14, 1572864
    s_mov_b32 s15, 1581056
    s_mov_b32 s16, 1835008
    s_mov_b32 s17, 1843200
    s_mov_b32 s60, 4194304
L_sp_55:
    buffer_load_dwordx4 v[8:11], v5, s[36:39], s14 offen sc1
    buffer_load_dwordx4 v[12:15], v5, s[36:39], s15 offen sc1
    buffer_load_dwordx4 v[16:19], v5, s[36:39], s16 offen sc1
    buffer_load_dwordx4 v[20:23], v5, s[36:39], s17 offen sc1
    s_waitcnt vmcnt(0)
    v_perm_b32 v1, v9, v8, s66
    v_perm_b32 v4, v11, v10, s67
    v_or_b32 v1, v1, v4
    v_cmp_ne_u32 s[6:7], s32, v1
    v_perm_b32 v1, v13, v12, s66
    v_perm_b32 v4, v15, v14, s67
    v_or_b32 v1, v1, v4
    v_cmp_ne_u32 s[8:9], s32, v1
    v_perm_b32 v1, v17, v16, s66
    v_perm_b32 v4, v19, v18, s67
    v_or_b32 v1, v1, v4
    v_cmp_ne_u32 s[10:11], s32, v1
    v_perm_b32 v1, v21, v20, s66
    v_perm_b32 v4, v23, v22, s67
    v_or_b32 v1, v1, v4
    v_cmp_ne_u32 s[12:13], s32, v1
    s_or_b64 s[6:7], s[6:7], s[8:9]
    s_or_b64 s[10:11], s[10:11], s[12:13]
    s_or_b64 s[6:7], s[6:7], s[10:11]
    s_cmp_eq_u64 s[6:7], 0
    s_cbranch_scc1 L_spd_56
    s_sleep 1
    s_sub_u32 s60, s60, 1
    s_cbranch_scc0 L_sp_55
L_spd_56:
    v_mov_b32 v8, s32
    v_mov_b32 v9, 0
    s_mov_b64 exec, 1
    buffer_store_dword v8, v9, s[36:39], 0 offen
L_end:
    s_endpgm
L_os_28:
    s_wqm_b64 s[8:9], vcc
    s_mov_b64 exec, -1
    s_cmp_eq_u32 s59, 0
    s_cbranch_scc0 L_sw_58
    s_mov_b32 s59, 1
    v_perm_b32 v104, v104, v199, s62
    v_perm_b32 v105, v105, v199, s63
    v_perm_b32 v106, v106, v199, s68
    v_perm_b32 v107, v107, v199, s69
    s_mov_b32 exec_lo, 0x00ff00ff
    s_mov_b32 exec_hi, 0x00ff00ff
    buffer_store_dwordx4 v[104:107], v219, s[36:39], s49 offen sc1
    s_cmp_lg_u32 s3, 0
    s_cbranch_scc1 L_sw_58
    s_mov_b64 exec, 0xff
    buffer_store_dwordx4 v[120:123], v124, s[36:39], s50 offen offset:2048 sc1
L_sw_58:
    s_mov_b64 exec, s[8:9]
L_o2_57:
    s_waitcnt vmcnt(0)
    v_perm_b32 v24, v9, v8, s66
    v_perm_b32 v25, v11, v10, s67
    v_or_b32 v24, v24, v25
    v_cmp_ne_u32 s[6:7], s46, v24
    v_perm_b32 v26, v13, v12, s66
    v_perm_b32 v27, v15, v14, s67
    v_or_b32 v26, v26, v27
    v_cmp_ne_u32 vcc, s46, v26
    s_nop 0
    s_or_b64 vcc, vcc, s[6:7]
    s_cbranch_vccz L_od_27
    s_wqm_b64 exec, vcc
    s_sleep 1
    s_add_u32 s56, s34, 1703936
    s_cmp_eq_u32 s61, s34
    s_cselect_b32 s61, s56, s34
    s_cselect_b32 s46, s32, s47
    buffer_load_dwordx4 v[8:11], v220, s[36:39], s61 offen sc1
    buffer_load_dwordx4 v[12:15], v220, s[36:39], s61 offen offset:128 sc1
    s_add_u32 s60, s60, 1
    s_cmp_lt_u32 s60, 4194304
    s_cbranch_scc1 L_o2_57
    s_waitcnt vmcnt(0)
    s_branch L_od_27
L_fps_38:
    s_mov_b64 exec, -1
    buffer_store_dwordx4 v[192:195], v196, s[36:39], s51 offen sc1
    s_add_u32 s61, s61, 262144
    s_waitcnt vmcnt(0)
L_fs2_59:
    s_mov_b64 exec, s[6:7]
    buffer_load_dwordx4 v[8:11], v5, s[36:39], s61 offen offset:0 sc1
    s_mov_b64 exec, s[8:9]
    buffer_load_dwordx4 v[12:15], v5, s[36:39], s61 offen offset:1024 sc1
    s_mov_b64 exec, s[10:11]
    buffer_load_dwordx4 v[16:19], v56, s[36:39], s61 offen offset:0 sc1
    s_mov_b64 exec, s[12:13]
    buffer_load_dwordx4 v[20:23], v56, s[36:39], s61 offen offset:1024 sc1
    s_mov_b64 exec, s[20:21]
    buffer_load_dwordx4 v[24:27], v46, s[36:39], s61 offen offset:0 sc1
    s_mov_b64 exec, s[24:25]
    buffer_load_dwordx4 v[28:31], v5, s[36:39], s96 offen sc1
    s_mov_b64 exec, -1
    s_waitcnt vmcnt(0)
    v_perm_b32 v61, v9, v8, s66
    v_perm_b32 v62, v11, v10, s67
    v_or_b32 v61, v61, v62
    v_cmp_ne_u32 s[6:7], s32, v61
    v_perm_b32 v1, v13, v12, s66
    v_perm_b32 v4, v15, v14, s67
    v_or_b32 v1, v1, v4
    v_cmp_ne_u32 s[8:9], s32, v1
    v_perm_b32 v61, v17, v16, s66
    v_perm_b32 v62, v19, v18, s67
    v_or_b32 v61, v61, v62
    v_cmp_ne_u32 s[10:11], s32, v61
    v_perm_b32 v1, v21, v20, s66
    v_perm_b32 v4, v23, v22, s67
    v_or_b32 v1, v1, v4
    v_cmp_ne_u32 s[12:13], s32, v1
    v_perm_b32 v61, v25, v24, s66
    v_perm_b32 v62, v27, v26, s67
    v_or_b32 v61, v61, v62
    v_cmp_ne_u32 s[20:21], s32, v61
    v_perm_b32 v1, v29, v28, s66
    v_perm_b32 v4, v31, v30, s67
    v_or_b32 v1, v1, v4
    v_cmp_ne_u32 s[24:25], s32, v1
    s_wqm_b64 s[6:7], s[6:7]
    s_and_b64 s[20:21], s[20:21], s[54:55]
    s_wqm_b64 s[8:9], s[8:9]
    s_wqm_b64 s[10:11], s[10:11]
    s_wqm_b64 s[12:13], s[12:13]
    s_wqm_b64 s[20:21], s[20:21]
    s_or_b64 s[52:53], s[6:7], s[8:9]
    s_and_b64 s[20:21], s[20:21], s[54:55]
    s_and_b64 s[24:25], s[24:25], 15
    s_wqm_b64 s[24:25], s[24:25]
    s_or_b64 s[52:53], s[52:53], s[10:11]
    s_or_b64 s[52:53], s[52:53], s[12:13]
    s_or_b64 s[52:53], s[52:53], s[20:21]
    s_or_b64 s[52:53], s[52:53], s[24:25]
    s_cbranch_scc0 L_fpd_37
    s_sleep 2
    s_add_u32 s60, s60, 1
    s_cmp_lt_u32 s60, 4194304
    s_cbranch_scc1 L_fs2_59
    s_branch L_fpd_37
L_codeend:
.if (L_codeend - L_pc) < 16384 + 640 - 120
.error "program shorter than the prefetched range"
.endif
.section .rodata,"a"
.p2align 6
.amdhsa_kernel recurrent_scan__sliding_block_cached__glu_gated_reglu__decode_kernel
.amdhsa_next_free_vgpr 256
.amdhsa_next_free_sgpr 102
.amdhsa_accum_offset 256
.amdhsa_group_segment_fixed_size 0
.amdhsa_kernarg_size 96
.amdhsa_user_sgpr_count 2
.amdhsa_user_sgpr_kernarg_segment_ptr 1
.amdhsa_system_sgpr_workgroup_id_x 1
.end_amdhsa_kernel
```
